```python
import torch

def _softmax(x, axis=-1):
    return torch.softmax(x, dim=axis)
def _gelu(x):
    return torch.nn.functional.gelu(x, approximate="tanh")
def _silu(x):
    return torch.nn.functional.silu(x)
def _sigmoid(x):
    return torch.sigmoid(x)
def _layernorm(x, axis=-1, eps=1e-5):
    m = x.mean(dim=axis, keepdim=True)
    v = x.var(dim=axis, keepdim=True, unbiased=False)
    return (x - m) / torch.sqrt(v + eps)
def _scatter_add(tgt, idx, src, axis=0):
    return tgt.clone().index_add_(axis, idx, src)
def _segment_sum(src, seg, n):
    out = torch.zeros((n,) + src.shape[1:], dtype=src.dtype)
    return out.index_add_(0, seg, src)
def _pad(x, pw):
    flat = tuple(v for pair in reversed(pw) for v in pair)
    return torch.nn.functional.pad(x, flat)

kernel_name = 'standalone__gqa_block_cached__decode'

def setup_inputs():

    _w = (lambda a: (lambda t: t.to(torch.bfloat16) if t.is_floating_point() else t)(torch.as_tensor(a)))
    B, Sq, D = 1, 1, 640
    Hq, Hkv, Sk, Dh = 32, 32, 32768, 192
    assert Hq % Hkv == 0, (Hq, Hkv)
    return {
        "x": _w((lambda *s: torch.randn(*s, dtype=torch.bfloat16) * 0.8)(B, Sq, D)),
        "k_cache": _w((lambda *s: torch.randn(*s, dtype=torch.bfloat16) * 0.8)(B, Hkv, Sk, Dh)),
        "v_cache": _w((lambda *s: torch.randn(*s, dtype=torch.bfloat16) * 0.05)(B, Hkv, Sk, Dh)),
        "wq": _w((lambda *s: torch.randn(*s, dtype=torch.bfloat16) * 0.8)(D, Hq * Dh) * (D ** -0.5)),
        "wo": _w((lambda *s: torch.randn(*s, dtype=torch.bfloat16) * 0.05)(Hq * Dh, D) * ((Hq * Dh) ** -0.5)),
    }

def reference(x, k_cache, v_cache, wq, wo):
    B, Sq, D = x.shape
    Hq, Dh = 32, 192
    Hkv = k_cache.shape[1]
    rep = Hq // Hkv
    q = (lambda x, *d: x.permute(*d))((x @ wq).reshape(B, Sq, Hq, Dh), 0, 2, 1, 3)
    k = (lambda x, n, axis: torch.repeat_interleave(x, n, dim=axis))(k_cache, rep, axis=1)
    v = (lambda x, n, axis: torch.repeat_interleave(x, n, dim=axis))(v_cache, rep, axis=1)
    scores = torch.einsum("bhqd,bhkd->bhqk", q, k) * (Dh ** -0.5)
    p = _softmax(scores, axis=-1)
    o = torch.einsum("bhqk,bhkd->bhqd", p, v)
    return (lambda x, *d: x.permute(*d))(o, 0, 2, 1, 3).reshape(B, Sq, Hq * Dh) @ wo
```

```asm
; @launch grid=(256,1,1) block=(320,1,1) lds=512
.amdgcn_target "amdgcn-amd-amdhsa--gfx950"
.text
.globl standalone__gqa_block_cached__decode_kernel
.p2align 8
.type standalone__gqa_block_cached__decode_kernel,@function
standalone__gqa_block_cached__decode_kernel:
    s_cmp_ge_u32 s2, 256
    s_cbranch_scc1 END0
    s_load_dwordx16 s[4:19], s[0:1], 0
    s_lshr_b32 s52, s2, 3
    s_and_b32 s53, s2, 7
    s_mov_b32 s54, s2
    v_lshrrev_b32 v9, 6, v0
    v_and_b32 v10, 7, v0
    v_readfirstlane_b32 s55, v9
    v_bfe_u32 v11, v0, 3, 3
    v_lshlrev_b32 v12, 4, v10
    s_cmp_eq_u32 s55, 0
    s_cbranch_scc1 HELPER
    v_mul_u32_u24 v1, 0x180, v11
    v_add_u32 v1, v1, v12
    s_mul_i32 s64, s52, 12582912
    s_mul_i32 s31, s52, 11
    s_lshl_b32 s60, s53, 2
    s_add_u32 s60, s60, s55
    s_add_u32 s60, s60, s31
    s_sub_u32 s60, s60, 1
    s_and_b32 s60, s60, 1023
    s_mul_i32 s60, s60, 12288
    s_waitcnt lgkmcnt(0)
    s_add_u32 s20, s6, s64
    s_addc_u32 s21, s7, 0
    s_mov_b32 s22, 12582912
    s_mov_b32 s23, 0x20000
    s_add_u32 s24, s8, s64
    s_addc_u32 s25, s9, 0
    s_mov_b32 s26, 12582912
    s_mov_b32 s27, 0x20000
    s_add_u32 s64, s60, 6144
    buffer_load_dwordx4 v[40:43], v1, s[20:23], s60 offen nt
    buffer_load_dwordx4 v[52:55], v1, s[24:27], s60 offen nt
    s_barrier
    buffer_load_dwordx4 v[44:47], v1, s[20:23], s60 offen offset:128 nt
    buffer_load_dwordx4 v[48:51], v1, s[20:23], s60 offen offset:256 nt
    buffer_load_dwordx4 v[64:67], v1, s[20:23], s60 offen offset:3072 nt
    buffer_load_dwordx4 v[68:71], v1, s[20:23], s60 offen offset:3200 nt
    buffer_load_dwordx4 v[72:75], v1, s[20:23], s60 offen offset:3328 nt
    buffer_load_dwordx4 v[88:91], v1, s[20:23], s64 offen nt
    buffer_load_dwordx4 v[92:95], v1, s[20:23], s64 offen offset:128 nt
    buffer_load_dwordx4 v[96:99], v1, s[20:23], s64 offen offset:256 nt
    buffer_load_dwordx4 v[112:115], v1, s[20:23], s64 offen offset:3072 nt
    buffer_load_dwordx4 v[116:119], v1, s[20:23], s64 offen offset:3200 nt
    buffer_load_dwordx4 v[120:123], v1, s[20:23], s64 offen offset:3328 nt
    buffer_load_dwordx4 v[56:59], v1, s[24:27], s60 offen offset:128 nt
    buffer_load_dwordx4 v[60:63], v1, s[24:27], s60 offen offset:256 nt
    buffer_load_dwordx4 v[76:79], v1, s[24:27], s60 offen offset:3072 nt
    buffer_load_dwordx4 v[80:83], v1, s[24:27], s60 offen offset:3200 nt
    buffer_load_dwordx4 v[84:87], v1, s[24:27], s60 offen offset:3328 nt
    buffer_load_dwordx4 v[100:103], v1, s[24:27], s64 offen nt
    buffer_load_dwordx4 v[104:107], v1, s[24:27], s64 offen offset:128 nt
    buffer_load_dwordx4 v[108:111], v1, s[24:27], s64 offen offset:256 nt
    buffer_load_dwordx4 v[124:127], v1, s[24:27], s64 offen offset:3072 nt
    buffer_load_dwordx4 v[128:131], v1, s[24:27], s64 offen offset:3200 nt
    buffer_load_dwordx4 v[132:135], v1, s[24:27], s64 offen offset:3328 nt
    s_add_u32 s60, s60, 12288
    s_add_u32 s30, s55, s53
    s_and_b32 s30, s30, 3
    s_lshl_b32 s61, s52, 2
    s_add_u32 s61, s61, s30
    s_mul_i32 s61, s61, 256
    s_add_u32 s61, s61, 0x281000
    s_add_u32 s96, s18, s61
    s_addc_u32 s97, s19, 0
    s_add_u32 s30, s30, s31
    s_lshl_b32 s30, s30, 1
    s_mov_b32 s32, 0x42106290
    s_mov_b32 s33, 0x10
    s_mov_b32 s98, 0xbce32a18
    s_mov_b32 s99, 0x3ff
    s_mov_b32 s28, 22
    s_mov_b32 s36, 20
    s_mov_b32 s29, 0
    s_mov_b32 s79, -2
    s_mov_b32 s40, s18
    s_mov_b32 s41, s19
    s_mov_b32 s42, 2752512
    s_mov_b32 s43, 0x20000
    s_mov_b32 s56, 0x3dd53b95
    v_and_b32 v13, 1, v10
    v_lshlrev_b32 v13, 4, v13
    v_mov_b32 v14, 0xffff
    v_lshlrev_b32 v13, v13, v14
    v_lshrrev_b32 v14, 1, v10
    v_cmp_eq_u32 vcc, 0, v14
    s_nop 1
    v_cndmask_b32 v16, 0, v13, vcc
    v_cmp_eq_u32 vcc, 1, v14
    s_nop 1
    v_cndmask_b32 v17, 0, v13, vcc
    v_cmp_eq_u32 vcc, 2, v14
    s_nop 1
    v_cndmask_b32 v18, 0, v13, vcc
    v_cmp_eq_u32 vcc, 3, v14
    s_nop 1
    v_cndmask_b32 v19, 0, v13, vcc
    s_mul_i32 s58, s54, 8448
    s_add_u32 s58, s58, 0xfffffc00
    v_lshlrev_b32 v232, 4, v0
    v_add_u32 v232, s58, v232
    s_call_b64 s[38:39], SLOW
    s_branch BLOOP
SLOW:
    v_mul_f32 v37, s56, v36
    s_nop 1
    v_max_f32_dpp v37, v37, v37 row_ror:8 row_mask:0xf bank_mask:0xf
    s_nop 1
    v_max_f32_dpp v37, v37, v37 row_bcast:15 row_mask:0xa bank_mask:0xf
    s_nop 1
    v_max_f32_dpp v37, v37, v37 row_bcast:31 row_mask:0xc bank_mask:0xf
    s_nop 1
    v_readlane_b32 s58, v37, 63
    s_nop 1
    v_min_f32_e64 v37, -s58, v3
    v_sub_f32 v38, v37, v3
    v_exp_f32 v38, v38
    v_mov_b32 v3, v37
    v_mul_f32 v20, v20, v38
    v_mul_f32 v21, v21, v38
    v_mul_f32 v22, v22, v38
    v_mul_f32 v23, v23, v38
    v_mul_f32 v24, v24, v38
    v_mul_f32 v25, v25, v38
    v_mul_f32 v26, v26, v38
    v_mul_f32 v27, v27, v38
    v_mul_f32 v28, v28, v38
    v_mul_f32 v29, v29, v38
    v_mul_f32 v30, v30, v38
    v_mul_f32 v31, v31, v38
    v_mul_f32 v2, v2, v38
    v_fma_f32 v39, v36, s56, v3
    s_setpc_b64 s[38:39]
BLOOP:
    s_cmp_eq_u32 s28, s36
    s_cbranch_scc1 XDISP
XBACK:
    s_add_u32 s60, s60, 380928
    s_sub_u32 s58, s60, 12582912
    s_cselect_b32 s60, s60, s58
    s_cmp_eq_u32 s28, 0
    s_cbranch_scc1 NEWRB
HAVERB:
    s_sub_u32 s28, s28, 2
    s_add_u32 s64, s60, 6144
    s_waitcnt vmcnt(21)
    v_dot2_f32_bf16 v236, v136, v4, 0
    v_dot2_f32_bf16 v237, v140, v8, 0
    v_dot2_f32_bf16 v238, v144, v12, 0
    v_dot2_f32_bf16 v236, v137, v5, v236
    v_dot2_f32_bf16 v237, v141, v9, v237
    v_dot2_f32_bf16 v238, v145, v13, v238
    v_dot2_f32_bf16 v236, v138, v6, v236
    v_dot2_f32_bf16 v237, v142, v10, v237
    v_dot2_f32_bf16 v238, v146, v14, v238
    v_dot2_f32_bf16 v236, v139, v7, v236
    v_dot2_f32_bf16 v237, v143, v11, v237
    v_dot2_f32_bf16 v238, v147, v15, v238
    s_waitcnt vmcnt(18)
    v_dot2_f32_bf16 v239, v160, v4, 0
    v_dot2_f32_bf16 v240, v164, v8, 0
    v_dot2_f32_bf16 v241, v168, v12, 0
    v_dot2_f32_bf16 v239, v161, v5, v239
    v_dot2_f32_bf16 v240, v165, v9, v240
    v_dot2_f32_bf16 v241, v169, v13, v241
    v_dot2_f32_bf16 v239, v162, v6, v239
    v_dot2_f32_bf16 v240, v166, v10, v240
    v_dot2_f32_bf16 v241, v170, v14, v241
    v_dot2_f32_bf16 v239, v163, v7, v239
    v_dot2_f32_bf16 v240, v167, v11, v240
    v_dot2_f32_bf16 v241, v171, v15, v241
    s_waitcnt vmcnt(15)
    v_dot2_f32_bf16 v242, v184, v4, 0
    v_dot2_f32_bf16 v243, v188, v8, 0
    v_dot2_f32_bf16 v244, v192, v12, 0
    v_dot2_f32_bf16 v242, v185, v5, v242
    v_dot2_f32_bf16 v243, v189, v9, v243
    v_dot2_f32_bf16 v244, v193, v13, v244
    v_dot2_f32_bf16 v242, v186, v6, v242
    v_dot2_f32_bf16 v243, v190, v10, v243
    v_dot2_f32_bf16 v244, v194, v14, v244
    v_dot2_f32_bf16 v242, v187, v7, v242
    v_dot2_f32_bf16 v243, v191, v11, v243
    v_dot2_f32_bf16 v244, v195, v15, v244
    s_waitcnt vmcnt(12)
    v_dot2_f32_bf16 v245, v208, v4, 0
    v_dot2_f32_bf16 v246, v212, v8, 0
    v_dot2_f32_bf16 v247, v216, v12, 0
    v_dot2_f32_bf16 v245, v209, v5, v245
    v_dot2_f32_bf16 v246, v213, v9, v246
    v_dot2_f32_bf16 v247, v217, v13, v247
    v_dot2_f32_bf16 v245, v210, v6, v245
    v_dot2_f32_bf16 v246, v214, v10, v246
    v_dot2_f32_bf16 v247, v218, v14, v247
    v_dot2_f32_bf16 v245, v211, v7, v245
    v_dot2_f32_bf16 v246, v215, v11, v246
    v_dot2_f32_bf16 v247, v219, v15, v247
    buffer_load_dwordx4 v[136:139], v1, s[20:23], s60 offen nt
    buffer_load_dwordx4 v[140:143], v1, s[20:23], s60 offen offset:128 nt
    buffer_load_dwordx4 v[144:147], v1, s[20:23], s60 offen offset:256 nt
    buffer_load_dwordx4 v[160:163], v1, s[20:23], s60 offen offset:3072 nt
    buffer_load_dwordx4 v[164:167], v1, s[20:23], s60 offen offset:3200 nt
    buffer_load_dwordx4 v[168:171], v1, s[20:23], s60 offen offset:3328 nt
    buffer_load_dwordx4 v[184:187], v1, s[20:23], s64 offen nt
    buffer_load_dwordx4 v[188:191], v1, s[20:23], s64 offen offset:128 nt
    buffer_load_dwordx4 v[192:195], v1, s[20:23], s64 offen offset:256 nt
    buffer_load_dwordx4 v[208:211], v1, s[20:23], s64 offen offset:3072 nt
    buffer_load_dwordx4 v[212:215], v1, s[20:23], s64 offen offset:3200 nt
    buffer_load_dwordx4 v[216:219], v1, s[20:23], s64 offen offset:3328 nt
    v_add_f32 v236, v236, v237
    v_add_f32 v239, v239, v240
    v_add_f32 v242, v242, v243
    v_add_f32 v245, v245, v246
    v_add_f32 v236, v236, v238
    v_add_f32 v239, v239, v241
    v_add_f32 v242, v242, v244
    v_add_f32 v245, v245, v247
    v_add_f32_dpp v236, v236, v236 quad_perm:[1,0,3,2] row_mask:0xf bank_mask:0xf
    v_add_f32_dpp v239, v239, v239 quad_perm:[1,0,3,2] row_mask:0xf bank_mask:0xf
    v_add_f32_dpp v242, v242, v242 quad_perm:[1,0,3,2] row_mask:0xf bank_mask:0xf
    v_add_f32_dpp v245, v245, v245 quad_perm:[1,0,3,2] row_mask:0xf bank_mask:0xf
    v_add_f32_dpp v236, v236, v236 quad_perm:[2,3,0,1] row_mask:0xf bank_mask:0xf
    v_add_f32_dpp v239, v239, v239 quad_perm:[2,3,0,1] row_mask:0xf bank_mask:0xf
    v_add_f32_dpp v242, v242, v242 quad_perm:[2,3,0,1] row_mask:0xf bank_mask:0xf
    v_add_f32_dpp v245, v245, v245 quad_perm:[2,3,0,1] row_mask:0xf bank_mask:0xf
    v_add_f32_dpp v236, v236, v236 row_half_mirror row_mask:0xf bank_mask:0xf
    v_add_f32_dpp v239, v239, v239 row_half_mirror row_mask:0xf bank_mask:0xf
    v_add_f32_dpp v242, v242, v242 row_half_mirror row_mask:0xf bank_mask:0xf
    v_add_f32_dpp v245, v245, v245 row_half_mirror row_mask:0xf bank_mask:0xf
    v_max3_f32 v36, v236, v239, v242
    v_max_f32 v36, v36, v245
    v_fma_f32 v39, v36, s56, v3
    v_cmp_lt_f32 vcc, 0, v39
    s_cbranch_vccz BACK_B
    s_call_b64 s[38:39], SLOW
BACK_B:
    v_fma_f32 v236, v236, s56, v3
    v_fma_f32 v239, v239, s56, v3
    v_fma_f32 v242, v242, s56, v3
    v_fma_f32 v245, v245, s56, v3
    v_exp_f32 v236, v236
    v_exp_f32 v239, v239
    v_exp_f32 v242, v242
    v_exp_f32 v245, v245
    v_cvt_pk_bf16_f32 v237, v236, v236
    v_cvt_pk_bf16_f32 v240, v239, v239
    v_cvt_pk_bf16_f32 v243, v242, v242
    v_cvt_pk_bf16_f32 v246, v245, v245
    v_and_b32 v32, v237, v16
    v_and_b32 v33, v237, v17
    v_and_b32 v34, v237, v18
    v_and_b32 v35, v237, v19
    v_add_f32 v236, v236, v239
    v_add_f32 v242, v242, v245
    v_add_f32 v2, v2, v236
    v_add_f32 v2, v2, v242
    v_and_b32 v248, v240, v16
    v_and_b32 v249, v240, v17
    v_and_b32 v250, v240, v18
    v_and_b32 v251, v240, v19
    s_waitcnt vmcnt(21)
    v_mfma_f32_16x16x32_bf16 v[20:23], v[32:35], v[148:151], v[20:23]
    v_mfma_f32_16x16x32_bf16 v[24:27], v[32:35], v[152:155], v[24:27]
    v_mfma_f32_16x16x32_bf16 v[28:31], v[32:35], v[156:159], v[28:31]
    v_and_b32 v252, v243, v16
    v_and_b32 v253, v243, v17
    v_and_b32 v254, v243, v18
    v_and_b32 v255, v243, v19
    s_waitcnt vmcnt(18)
    v_mfma_f32_16x16x32_bf16 v[20:23], v[248:251], v[172:175], v[20:23]
    v_mfma_f32_16x16x32_bf16 v[24:27], v[248:251], v[176:179], v[24:27]
    v_mfma_f32_16x16x32_bf16 v[28:31], v[248:251], v[180:183], v[28:31]
    v_and_b32 v32, v246, v16
    v_and_b32 v33, v246, v17
    v_and_b32 v34, v246, v18
    v_and_b32 v35, v246, v19
    s_waitcnt vmcnt(15)
    v_mfma_f32_16x16x32_bf16 v[20:23], v[252:255], v[196:199], v[20:23]
    v_mfma_f32_16x16x32_bf16 v[24:27], v[252:255], v[200:203], v[24:27]
    v_mfma_f32_16x16x32_bf16 v[28:31], v[252:255], v[204:207], v[28:31]
    s_waitcnt vmcnt(12)
    v_mfma_f32_16x16x32_bf16 v[20:23], v[32:35], v[220:223], v[20:23]
    v_mfma_f32_16x16x32_bf16 v[24:27], v[32:35], v[224:227], v[24:27]
    v_mfma_f32_16x16x32_bf16 v[28:31], v[32:35], v[228:231], v[28:31]
    buffer_load_dwordx4 v[148:151], v1, s[24:27], s60 offen nt
    buffer_load_dwordx4 v[152:155], v1, s[24:27], s60 offen offset:128 nt
    buffer_load_dwordx4 v[156:159], v1, s[24:27], s60 offen offset:256 nt
    buffer_load_dwordx4 v[172:175], v1, s[24:27], s60 offen offset:3072 nt
    buffer_load_dwordx4 v[176:179], v1, s[24:27], s60 offen offset:3200 nt
    buffer_load_dwordx4 v[180:183], v1, s[24:27], s60 offen offset:3328 nt
    buffer_load_dwordx4 v[196:199], v1, s[24:27], s64 offen nt
    buffer_load_dwordx4 v[200:203], v1, s[24:27], s64 offen offset:128 nt
    buffer_load_dwordx4 v[204:207], v1, s[24:27], s64 offen offset:256 nt
    buffer_load_dwordx4 v[220:223], v1, s[24:27], s64 offen offset:3072 nt
    buffer_load_dwordx4 v[224:227], v1, s[24:27], s64 offen offset:3200 nt
    buffer_load_dwordx4 v[228:231], v1, s[24:27], s64 offen offset:3328 nt
    s_add_u32 s60, s60, 12288
    s_cmp_lg_u32 s28, 0
    s_cbranch_scc1 BLOOP
    s_mov_b32 s79, 1
    s_atomic_add s79, s[96:97], 0 glc
    s_branch BLOOP
LOOP:
    s_add_u32 s60, s60, 380928
    s_sub_u32 s58, s60, 12582912
    s_cselect_b32 s60, s60, s58
    s_cmp_eq_u32 s28, 0
    s_cbranch_scc1 NEWR0
HAVER0:
    s_sub_u32 s28, s28, 1
    s_cmp_lg_u32 s28, s29
    s_cbranch_scc1 NOCL0
    s_mov_b32 s79, 1
    s_atomic_add s79, s[96:97], 0 glc
NOCL0:
    s_waitcnt vmcnt(21)
    v_dot2_f32_bf16 v36, v136, v4, 0
    v_dot2_f32_bf16 v37, v140, v8, 0
    v_dot2_f32_bf16 v38, v144, v12, 0
    v_dot2_f32_bf16 v36, v137, v5, v36
    v_dot2_f32_bf16 v37, v141, v9, v37
    v_dot2_f32_bf16 v38, v145, v13, v38
    v_dot2_f32_bf16 v36, v138, v6, v36
    v_dot2_f32_bf16 v37, v142, v10, v37
    v_dot2_f32_bf16 v38, v146, v14, v38
    v_dot2_f32_bf16 v36, v139, v7, v36
    v_dot2_f32_bf16 v37, v143, v11, v37
    v_dot2_f32_bf16 v38, v147, v15, v38
    buffer_load_dwordx4 v[136:139], v1, s[20:23], s60 offen nt
    buffer_load_dwordx4 v[140:143], v1, s[20:23], s60 offen offset:128 nt
    buffer_load_dwordx4 v[144:147], v1, s[20:23], s60 offen offset:256 nt
    v_add_f32 v36, v36, v37
    v_add_f32 v36, v36, v38
    s_nop 1
    v_add_f32_dpp v36, v36, v36 quad_perm:[1,0,3,2] row_mask:0xf bank_mask:0xf
    s_nop 1
    v_add_f32_dpp v36, v36, v36 quad_perm:[2,3,0,1] row_mask:0xf bank_mask:0xf
    s_nop 1
    v_add_f32_dpp v36, v36, v36 row_half_mirror row_mask:0xf bank_mask:0xf
    v_fma_f32 v39, v36, s56, v3
    v_cmp_lt_f32 vcc, 0, v39
    s_cbranch_vccz BACK_L00
    s_call_b64 s[38:39], SLOW
BACK_L00:
    v_exp_f32 v39, v39
    s_nop 0
    v_cvt_pk_bf16_f32 v37, v39, v39
    v_add_f32 v2, v2, v39
    v_and_b32 v32, v37, v16
    v_and_b32 v33, v37, v17
    v_and_b32 v34, v37, v18
    v_and_b32 v35, v37, v19
    s_waitcnt vmcnt(21)
    s_nop 0
    v_mfma_f32_16x16x32_bf16 v[20:23], v[32:35], v[148:151], v[20:23]
    v_mfma_f32_16x16x32_bf16 v[24:27], v[32:35], v[152:155], v[24:27]
    v_mfma_f32_16x16x32_bf16 v[28:31], v[32:35], v[156:159], v[28:31]
    buffer_load_dwordx4 v[148:151], v1, s[24:27], s60 offen nt
    buffer_load_dwordx4 v[152:155], v1, s[24:27], s60 offen offset:128 nt
    buffer_load_dwordx4 v[156:159], v1, s[24:27], s60 offen offset:256 nt
    s_add_u32 s60, s60, 3072
    s_waitcnt vmcnt(21)
    v_dot2_f32_bf16 v36, v160, v4, 0
    v_dot2_f32_bf16 v37, v164, v8, 0
    v_dot2_f32_bf16 v38, v168, v12, 0
    v_dot2_f32_bf16 v36, v161, v5, v36
    v_dot2_f32_bf16 v37, v165, v9, v37
    v_dot2_f32_bf16 v38, v169, v13, v38
    v_dot2_f32_bf16 v36, v162, v6, v36
    v_dot2_f32_bf16 v37, v166, v10, v37
    v_dot2_f32_bf16 v38, v170, v14, v38
    v_dot2_f32_bf16 v36, v163, v7, v36
    v_dot2_f32_bf16 v37, v167, v11, v37
    v_dot2_f32_bf16 v38, v171, v15, v38
    buffer_load_dwordx4 v[160:163], v1, s[20:23], s60 offen nt
    buffer_load_dwordx4 v[164:167], v1, s[20:23], s60 offen offset:128 nt
    buffer_load_dwordx4 v[168:171], v1, s[20:23], s60 offen offset:256 nt
    v_add_f32 v36, v36, v37
    v_add_f32 v36, v36, v38
    s_nop 1
    v_add_f32_dpp v36, v36, v36 quad_perm:[1,0,3,2] row_mask:0xf bank_mask:0xf
    s_nop 1
    v_add_f32_dpp v36, v36, v36 quad_perm:[2,3,0,1] row_mask:0xf bank_mask:0xf
    s_nop 1
    v_add_f32_dpp v36, v36, v36 row_half_mirror row_mask:0xf bank_mask:0xf
    v_fma_f32 v39, v36, s56, v3
    v_cmp_lt_f32 vcc, 0, v39
    s_cbranch_vccz BACK_L01
    s_call_b64 s[38:39], SLOW
BACK_L01:
    v_exp_f32 v39, v39
    s_nop 0
    v_cvt_pk_bf16_f32 v37, v39, v39
    v_add_f32 v2, v2, v39
    v_and_b32 v32, v37, v16
    v_and_b32 v33, v37, v17
    v_and_b32 v34, v37, v18
    v_and_b32 v35, v37, v19
    s_waitcnt vmcnt(21)
    s_nop 0
    v_mfma_f32_16x16x32_bf16 v[20:23], v[32:35], v[172:175], v[20:23]
    v_mfma_f32_16x16x32_bf16 v[24:27], v[32:35], v[176:179], v[24:27]
    v_mfma_f32_16x16x32_bf16 v[28:31], v[32:35], v[180:183], v[28:31]
    buffer_load_dwordx4 v[172:175], v1, s[24:27], s60 offen nt
    buffer_load_dwordx4 v[176:179], v1, s[24:27], s60 offen offset:128 nt
    buffer_load_dwordx4 v[180:183], v1, s[24:27], s60 offen offset:256 nt
    s_add_u32 s60, s60, 3072
    s_cmp_eq_u32 s28, 0
    s_cbranch_scc1 NEWR1
HAVER1:
    s_sub_u32 s28, s28, 1
    s_cmp_lg_u32 s28, s29
    s_cbranch_scc1 NOCL1
    s_mov_b32 s79, 1
    s_atomic_add s79, s[96:97], 0 glc
NOCL1:
    s_waitcnt vmcnt(21)
    v_dot2_f32_bf16 v36, v184, v4, 0
    v_dot2_f32_bf16 v37, v188, v8, 0
    v_dot2_f32_bf16 v38, v192, v12, 0
    v_dot2_f32_bf16 v36, v185, v5, v36
    v_dot2_f32_bf16 v37, v189, v9, v37
    v_dot2_f32_bf16 v38, v193, v13, v38
    v_dot2_f32_bf16 v36, v186, v6, v36
    v_dot2_f32_bf16 v37, v190, v10, v37
    v_dot2_f32_bf16 v38, v194, v14, v38
    v_dot2_f32_bf16 v36, v187, v7, v36
    v_dot2_f32_bf16 v37, v191, v11, v37
    v_dot2_f32_bf16 v38, v195, v15, v38
    buffer_load_dwordx4 v[184:187], v1, s[20:23], s60 offen nt
    buffer_load_dwordx4 v[188:191], v1, s[20:23], s60 offen offset:128 nt
    buffer_load_dwordx4 v[192:195], v1, s[20:23], s60 offen offset:256 nt
    v_add_f32 v36, v36, v37
    v_add_f32 v36, v36, v38
    s_nop 1
    v_add_f32_dpp v36, v36, v36 quad_perm:[1,0,3,2] row_mask:0xf bank_mask:0xf
    s_nop 1
    v_add_f32_dpp v36, v36, v36 quad_perm:[2,3,0,1] row_mask:0xf bank_mask:0xf
    s_nop 1
    v_add_f32_dpp v36, v36, v36 row_half_mirror row_mask:0xf bank_mask:0xf
    v_fma_f32 v39, v36, s56, v3
    v_cmp_lt_f32 vcc, 0, v39
    s_cbranch_vccz BACK_L10
    s_call_b64 s[38:39], SLOW
BACK_L10:
    v_exp_f32 v39, v39
    s_nop 0
    v_cvt_pk_bf16_f32 v37, v39, v39
    v_add_f32 v2, v2, v39
    v_and_b32 v32, v37, v16
    v_and_b32 v33, v37, v17
    v_and_b32 v34, v37, v18
    v_and_b32 v35, v37, v19
    s_waitcnt vmcnt(21)
    s_nop 0
    v_mfma_f32_16x16x32_bf16 v[20:23], v[32:35], v[196:199], v[20:23]
    v_mfma_f32_16x16x32_bf16 v[24:27], v[32:35], v[200:203], v[24:27]
    v_mfma_f32_16x16x32_bf16 v[28:31], v[32:35], v[204:207], v[28:31]
    buffer_load_dwordx4 v[196:199], v1, s[24:27], s60 offen nt
    buffer_load_dwordx4 v[200:203], v1, s[24:27], s60 offen offset:128 nt
    buffer_load_dwordx4 v[204:207], v1, s[24:27], s60 offen offset:256 nt
    s_add_u32 s60, s60, 3072
    s_waitcnt vmcnt(21)
    v_dot2_f32_bf16 v36, v208, v4, 0
    v_dot2_f32_bf16 v37, v212, v8, 0
    v_dot2_f32_bf16 v38, v216, v12, 0
    v_dot2_f32_bf16 v36, v209, v5, v36
    v_dot2_f32_bf16 v37, v213, v9, v37
    v_dot2_f32_bf16 v38, v217, v13, v38
    v_dot2_f32_bf16 v36, v210, v6, v36
    v_dot2_f32_bf16 v37, v214, v10, v37
    v_dot2_f32_bf16 v38, v218, v14, v38
    v_dot2_f32_bf16 v36, v211, v7, v36
    v_dot2_f32_bf16 v37, v215, v11, v37
    v_dot2_f32_bf16 v38, v219, v15, v38
    buffer_load_dwordx4 v[208:211], v1, s[20:23], s60 offen nt
    buffer_load_dwordx4 v[212:215], v1, s[20:23], s60 offen offset:128 nt
    buffer_load_dwordx4 v[216:219], v1, s[20:23], s60 offen offset:256 nt
    v_add_f32 v36, v36, v37
    v_add_f32 v36, v36, v38
    s_nop 1
    v_add_f32_dpp v36, v36, v36 quad_perm:[1,0,3,2] row_mask:0xf bank_mask:0xf
    s_nop 1
    v_add_f32_dpp v36, v36, v36 quad_perm:[2,3,0,1] row_mask:0xf bank_mask:0xf
    s_nop 1
    v_add_f32_dpp v36, v36, v36 row_half_mirror row_mask:0xf bank_mask:0xf
    v_fma_f32 v39, v36, s56, v3
    v_cmp_lt_f32 vcc, 0, v39
    s_cbranch_vccz BACK_L11
    s_call_b64 s[38:39], SLOW
BACK_L11:
    v_exp_f32 v39, v39
    s_nop 0
    v_cvt_pk_bf16_f32 v37, v39, v39
    v_add_f32 v2, v2, v39
    v_and_b32 v32, v37, v16
    v_and_b32 v33, v37, v17
    v_and_b32 v34, v37, v18
    v_and_b32 v35, v37, v19
    s_waitcnt vmcnt(21)
    s_nop 0
    v_mfma_f32_16x16x32_bf16 v[20:23], v[32:35], v[220:223], v[20:23]
    v_mfma_f32_16x16x32_bf16 v[24:27], v[32:35], v[224:227], v[24:27]
    v_mfma_f32_16x16x32_bf16 v[28:31], v[32:35], v[228:231], v[28:31]
    buffer_load_dwordx4 v[220:223], v1, s[24:27], s60 offen nt
    buffer_load_dwordx4 v[224:227], v1, s[24:27], s60 offen offset:128 nt
    buffer_load_dwordx4 v[228:231], v1, s[24:27], s60 offen offset:256 nt
    s_add_u32 s60, s60, 3072
    s_branch LOOP
XDISP:
    s_cmp_lg_u32 s28, 20
    s_cbranch_scc1 XBLK
    s_mul_i32 s58, s55, 2
    s_sub_u32 s36, s36, s58
    v_mov_b32 v2, 0
    v_mov_b32 v3, 0x7f800000
    s_nop 3
    v_mov_b32 v20, 0
    v_mov_b32 v21, 0
    v_mov_b32 v22, 0
    v_mov_b32 v23, 0
    v_mov_b32 v24, 0
    v_mov_b32 v25, 0
    v_mov_b32 v26, 0
    v_mov_b32 v27, 0
    v_mov_b32 v28, 0
    v_mov_b32 v29, 0
    v_mov_b32 v30, 0
    v_mov_b32 v31, 0
    s_barrier
    ds_read_b128 v[4:7], v12 offset:0
    ds_read_b128 v[8:11], v12 offset:128
    ds_read_b128 v[12:15], v12 offset:256
    s_waitcnt lgkmcnt(0)
    s_branch XBACK
NEWRB:
    s_waitcnt lgkmcnt(0)
    s_add_u32 s58, s79, 1
    s_cmp_ge_u32 s58, 56
    s_cbranch_scc1 DRAINB
    s_lshr_b32 s59, s58, 3
    s_and_b32 s58, s58, 7
    s_mul_i32 s58, s58, 8
    s_add_u32 s58, s58, s30
    s_mul_i32 s59, s59, 6
    s_lshr_b64 s[64:65], s[32:33], s59
    s_and_b32 s28, s64, 63
    s_lshr_b64 s[64:65], s[98:99], s59
    s_and_b32 s65, s64, 1
    s_add_u32 s58, s58, s65
    s_and_b32 s64, s64, 62
    s_lshl_b32 s64, s64, 5
    s_add_u32 s58, s58, s64
    s_and_b32 s58, s58, 2047
    s_mul_i32 s60, s58, 6144
    s_cmp_ge_u32 s28, 2
    s_cbranch_scc1 HAVERB
    s_waitcnt vmcnt(0)
    s_branch HAVER0
DRAINB:
    s_waitcnt vmcnt(0)
    s_branch DRAIN0
NEWR0:
    s_waitcnt lgkmcnt(0)
    s_add_u32 s58, s79, 1
    s_cmp_ge_u32 s58, 56
    s_cbranch_scc1 DRAIN0
    s_lshr_b32 s59, s58, 3
    s_and_b32 s58, s58, 7
    s_mul_i32 s58, s58, 8
    s_add_u32 s58, s58, s30
    s_mul_i32 s59, s59, 6
    s_lshr_b64 s[64:65], s[32:33], s59
    s_and_b32 s28, s64, 63
    s_lshr_b64 s[64:65], s[98:99], s59
    s_and_b32 s65, s64, 1
    s_add_u32 s58, s58, s65
    s_and_b32 s64, s64, 62
    s_lshl_b32 s64, s64, 5
    s_add_u32 s58, s58, s64
    s_and_b32 s58, s58, 2047
    s_mul_i32 s60, s58, 6144
    s_branch HAVER0
DRAIN0:
    s_mov_b32 s28, 2
    s_branch DTOP0
NEWR1:
    s_waitcnt lgkmcnt(0)
    s_add_u32 s58, s79, 1
    s_cmp_ge_u32 s58, 56
    s_cbranch_scc1 DRAIN1
    s_lshr_b32 s59, s58, 3
    s_and_b32 s58, s58, 7
    s_mul_i32 s58, s58, 8
    s_add_u32 s58, s58, s30
    s_mul_i32 s59, s59, 6
    s_lshr_b64 s[64:65], s[32:33], s59
    s_and_b32 s28, s64, 63
    s_lshr_b64 s[64:65], s[98:99], s59
    s_and_b32 s65, s64, 1
    s_add_u32 s58, s58, s65
    s_and_b32 s64, s64, 62
    s_lshl_b32 s64, s64, 5
    s_add_u32 s58, s58, s64
    s_and_b32 s58, s58, 2047
    s_mul_i32 s60, s58, 6144
    s_branch HAVER1
DRAIN1:
    s_mov_b32 s28, 2
    s_branch DTOP1
XBLK:
    s_mov_b32 s36, -1
    v_dot2_f32_bf16 v36, v40, v4, 0
    v_dot2_f32_bf16 v37, v44, v8, 0
    v_dot2_f32_bf16 v38, v48, v12, 0
    v_dot2_f32_bf16 v36, v41, v5, v36
    v_dot2_f32_bf16 v37, v45, v9, v37
    v_dot2_f32_bf16 v38, v49, v13, v38
    v_dot2_f32_bf16 v36, v42, v6, v36
    v_dot2_f32_bf16 v37, v46, v10, v37
    v_dot2_f32_bf16 v38, v50, v14, v38
    v_dot2_f32_bf16 v36, v43, v7, v36
    v_dot2_f32_bf16 v37, v47, v11, v37
    v_dot2_f32_bf16 v38, v51, v15, v38
    s_nop 2
    v_add_f32 v36, v36, v37
    v_add_f32 v36, v36, v38
    s_nop 1
    v_add_f32_dpp v36, v36, v36 quad_perm:[1,0,3,2] row_mask:0xf bank_mask:0xf
    s_nop 1
    v_add_f32_dpp v36, v36, v36 quad_perm:[2,3,0,1] row_mask:0xf bank_mask:0xf
    s_nop 1
    v_add_f32_dpp v36, v36, v36 row_half_mirror row_mask:0xf bank_mask:0xf
    v_fma_f32 v39, v36, s56, v3
    v_cmp_lt_f32 vcc, 0, v39
    s_cbranch_vccz BACK_X0
    s_call_b64 s[38:39], SLOW
BACK_X0:
    v_exp_f32 v39, v39
    s_nop 0
    v_cvt_pk_bf16_f32 v37, v39, v39
    v_add_f32 v2, v2, v39
    v_and_b32 v32, v37, v16
    v_and_b32 v33, v37, v17
    v_and_b32 v34, v37, v18
    v_and_b32 v35, v37, v19
    s_nop 1
    v_mfma_f32_16x16x32_bf16 v[20:23], v[32:35], v[52:55], v[20:23]
    v_mfma_f32_16x16x32_bf16 v[24:27], v[32:35], v[56:59], v[24:27]
    v_mfma_f32_16x16x32_bf16 v[28:31], v[32:35], v[60:63], v[28:31]
    v_dot2_f32_bf16 v36, v64, v4, 0
    v_dot2_f32_bf16 v37, v68, v8, 0
    v_dot2_f32_bf16 v38, v72, v12, 0
    v_dot2_f32_bf16 v36, v65, v5, v36
    v_dot2_f32_bf16 v37, v69, v9, v37
    v_dot2_f32_bf16 v38, v73, v13, v38
    v_dot2_f32_bf16 v36, v66, v6, v36
    v_dot2_f32_bf16 v37, v70, v10, v37
    v_dot2_f32_bf16 v38, v74, v14, v38
    v_dot2_f32_bf16 v36, v67, v7, v36
    v_dot2_f32_bf16 v37, v71, v11, v37
    v_dot2_f32_bf16 v38, v75, v15, v38
    s_nop 2
    v_add_f32 v36, v36, v37
    v_add_f32 v36, v36, v38
    s_nop 1
    v_add_f32_dpp v36, v36, v36 quad_perm:[1,0,3,2] row_mask:0xf bank_mask:0xf
    s_nop 1
    v_add_f32_dpp v36, v36, v36 quad_perm:[2,3,0,1] row_mask:0xf bank_mask:0xf
    s_nop 1
    v_add_f32_dpp v36, v36, v36 row_half_mirror row_mask:0xf bank_mask:0xf
    v_fma_f32 v39, v36, s56, v3
    v_cmp_lt_f32 vcc, 0, v39
    s_cbranch_vccz BACK_X1
    s_call_b64 s[38:39], SLOW
BACK_X1:
    v_exp_f32 v39, v39
    s_nop 0
    v_cvt_pk_bf16_f32 v37, v39, v39
    v_add_f32 v2, v2, v39
    v_and_b32 v32, v37, v16
    v_and_b32 v33, v37, v17
    v_and_b32 v34, v37, v18
    v_and_b32 v35, v37, v19
    s_nop 1
    v_mfma_f32_16x16x32_bf16 v[20:23], v[32:35], v[76:79], v[20:23]
    v_mfma_f32_16x16x32_bf16 v[24:27], v[32:35], v[80:83], v[24:27]
    v_mfma_f32_16x16x32_bf16 v[28:31], v[32:35], v[84:87], v[28:31]
    v_dot2_f32_bf16 v36, v88, v4, 0
    v_dot2_f32_bf16 v37, v92, v8, 0
    v_dot2_f32_bf16 v38, v96, v12, 0
    v_dot2_f32_bf16 v36, v89, v5, v36
    v_dot2_f32_bf16 v37, v93, v9, v37
    v_dot2_f32_bf16 v38, v97, v13, v38
    v_dot2_f32_bf16 v36, v90, v6, v36
    v_dot2_f32_bf16 v37, v94, v10, v37
    v_dot2_f32_bf16 v38, v98, v14, v38
    v_dot2_f32_bf16 v36, v91, v7, v36
    v_dot2_f32_bf16 v37, v95, v11, v37
    v_dot2_f32_bf16 v38, v99, v15, v38
    s_nop 2
    v_add_f32 v36, v36, v37
    v_add_f32 v36, v36, v38
    s_nop 1
    v_add_f32_dpp v36, v36, v36 quad_perm:[1,0,3,2] row_mask:0xf bank_mask:0xf
    s_nop 1
    v_add_f32_dpp v36, v36, v36 quad_perm:[2,3,0,1] row_mask:0xf bank_mask:0xf
    s_nop 1
    v_add_f32_dpp v36, v36, v36 row_half_mirror row_mask:0xf bank_mask:0xf
    v_fma_f32 v39, v36, s56, v3
    v_cmp_lt_f32 vcc, 0, v39
    s_cbranch_vccz BACK_X2
    s_call_b64 s[38:39], SLOW
BACK_X2:
    v_exp_f32 v39, v39
    s_nop 0
    v_cvt_pk_bf16_f32 v37, v39, v39
    v_add_f32 v2, v2, v39
    v_and_b32 v32, v37, v16
    v_and_b32 v33, v37, v17
    v_and_b32 v34, v37, v18
    v_and_b32 v35, v37, v19
    s_nop 1
    v_mfma_f32_16x16x32_bf16 v[20:23], v[32:35], v[100:103], v[20:23]
    v_mfma_f32_16x16x32_bf16 v[24:27], v[32:35], v[104:107], v[24:27]
    v_mfma_f32_16x16x32_bf16 v[28:31], v[32:35], v[108:111], v[28:31]
    v_dot2_f32_bf16 v36, v112, v4, 0
    v_dot2_f32_bf16 v37, v116, v8, 0
    v_dot2_f32_bf16 v38, v120, v12, 0
    v_dot2_f32_bf16 v36, v113, v5, v36
    v_dot2_f32_bf16 v37, v117, v9, v37
    v_dot2_f32_bf16 v38, v121, v13, v38
    v_dot2_f32_bf16 v36, v114, v6, v36
    v_dot2_f32_bf16 v37, v118, v10, v37
    v_dot2_f32_bf16 v38, v122, v14, v38
    v_dot2_f32_bf16 v36, v115, v7, v36
    v_dot2_f32_bf16 v37, v119, v11, v37
    v_dot2_f32_bf16 v38, v123, v15, v38
    s_nop 2
    v_add_f32 v36, v36, v37
    v_add_f32 v36, v36, v38
    s_nop 1
    v_add_f32_dpp v36, v36, v36 quad_perm:[1,0,3,2] row_mask:0xf bank_mask:0xf
    s_nop 1
    v_add_f32_dpp v36, v36, v36 quad_perm:[2,3,0,1] row_mask:0xf bank_mask:0xf
    s_nop 1
    v_add_f32_dpp v36, v36, v36 row_half_mirror row_mask:0xf bank_mask:0xf
    v_fma_f32 v39, v36, s56, v3
    v_cmp_lt_f32 vcc, 0, v39
    s_cbranch_vccz BACK_X3
    s_call_b64 s[38:39], SLOW
BACK_X3:
    v_exp_f32 v39, v39
    s_nop 0
    v_cvt_pk_bf16_f32 v37, v39, v39
    v_add_f32 v2, v2, v39
    v_and_b32 v32, v37, v16
    v_and_b32 v33, v37, v17
    v_and_b32 v34, v37, v18
    v_and_b32 v35, v37, v19
    s_nop 1
    v_mfma_f32_16x16x32_bf16 v[20:23], v[32:35], v[124:127], v[20:23]
    v_mfma_f32_16x16x32_bf16 v[24:27], v[32:35], v[128:131], v[24:27]
    v_mfma_f32_16x16x32_bf16 v[28:31], v[32:35], v[132:135], v[28:31]
    s_branch XBACK
DTOP0:
    s_sub_u32 s28, s28, 1
    s_cbranch_scc1 FINDONE
    s_waitcnt vmcnt(12)
    s_cmp_gt_u32 s28, 0
DGO0:
    s_cbranch_scc1 WK_D00
    s_waitcnt vmcnt(9)
WK_D00:
    v_dot2_f32_bf16 v36, v136, v4, 0
    v_dot2_f32_bf16 v37, v140, v8, 0
    v_dot2_f32_bf16 v38, v144, v12, 0
    v_dot2_f32_bf16 v36, v137, v5, v36
    v_dot2_f32_bf16 v37, v141, v9, v37
    v_dot2_f32_bf16 v38, v145, v13, v38
    v_dot2_f32_bf16 v36, v138, v6, v36
    v_dot2_f32_bf16 v37, v142, v10, v37
    v_dot2_f32_bf16 v38, v146, v14, v38
    v_dot2_f32_bf16 v36, v139, v7, v36
    v_dot2_f32_bf16 v37, v143, v11, v37
    v_dot2_f32_bf16 v38, v147, v15, v38
    s_nop 2
    v_add_f32 v36, v36, v37
    v_add_f32 v36, v36, v38
    s_nop 1
    v_add_f32_dpp v36, v36, v36 quad_perm:[1,0,3,2] row_mask:0xf bank_mask:0xf
    s_nop 1
    v_add_f32_dpp v36, v36, v36 quad_perm:[2,3,0,1] row_mask:0xf bank_mask:0xf
    s_nop 1
    v_add_f32_dpp v36, v36, v36 row_half_mirror row_mask:0xf bank_mask:0xf
    v_fma_f32 v39, v36, s56, v3
    v_cmp_lt_f32 vcc, 0, v39
    s_cbranch_vccz BACK_D00
    s_call_b64 s[38:39], SLOW
BACK_D00:
    v_exp_f32 v39, v39
    s_nop 0
    v_cvt_pk_bf16_f32 v37, v39, v39
    v_add_f32 v2, v2, v39
    v_and_b32 v32, v37, v16
    v_and_b32 v33, v37, v17
    v_and_b32 v34, v37, v18
    v_and_b32 v35, v37, v19
    s_cbranch_scc1 WV_D00
    s_waitcnt vmcnt(6)
WV_D00:
    s_nop 0
    v_mfma_f32_16x16x32_bf16 v[20:23], v[32:35], v[148:151], v[20:23]
    v_mfma_f32_16x16x32_bf16 v[24:27], v[32:35], v[152:155], v[24:27]
    v_mfma_f32_16x16x32_bf16 v[28:31], v[32:35], v[156:159], v[28:31]
    s_cbranch_scc1 WK_D01
    s_waitcnt vmcnt(3)
WK_D01:
    v_dot2_f32_bf16 v36, v160, v4, 0
    v_dot2_f32_bf16 v37, v164, v8, 0
    v_dot2_f32_bf16 v38, v168, v12, 0
    v_dot2_f32_bf16 v36, v161, v5, v36
    v_dot2_f32_bf16 v37, v165, v9, v37
    v_dot2_f32_bf16 v38, v169, v13, v38
    v_dot2_f32_bf16 v36, v162, v6, v36
    v_dot2_f32_bf16 v37, v166, v10, v37
    v_dot2_f32_bf16 v38, v170, v14, v38
    v_dot2_f32_bf16 v36, v163, v7, v36
    v_dot2_f32_bf16 v37, v167, v11, v37
    v_dot2_f32_bf16 v38, v171, v15, v38
    s_nop 2
    v_add_f32 v36, v36, v37
    v_add_f32 v36, v36, v38
    s_nop 1
    v_add_f32_dpp v36, v36, v36 quad_perm:[1,0,3,2] row_mask:0xf bank_mask:0xf
    s_nop 1
    v_add_f32_dpp v36, v36, v36 quad_perm:[2,3,0,1] row_mask:0xf bank_mask:0xf
    s_nop 1
    v_add_f32_dpp v36, v36, v36 row_half_mirror row_mask:0xf bank_mask:0xf
    v_fma_f32 v39, v36, s56, v3
    v_cmp_lt_f32 vcc, 0, v39
    s_cbranch_vccz BACK_D01
    s_call_b64 s[38:39], SLOW
BACK_D01:
    v_exp_f32 v39, v39
    s_nop 0
    v_cvt_pk_bf16_f32 v37, v39, v39
    v_add_f32 v2, v2, v39
    v_and_b32 v32, v37, v16
    v_and_b32 v33, v37, v17
    v_and_b32 v34, v37, v18
    v_and_b32 v35, v37, v19
    s_cbranch_scc1 WV_D01
    s_waitcnt vmcnt(0)
WV_D01:
    s_nop 0
    v_mfma_f32_16x16x32_bf16 v[20:23], v[32:35], v[172:175], v[20:23]
    v_mfma_f32_16x16x32_bf16 v[24:27], v[32:35], v[176:179], v[24:27]
    v_mfma_f32_16x16x32_bf16 v[28:31], v[32:35], v[180:183], v[28:31]
DTOP1:
    s_sub_u32 s28, s28, 1
    s_cbranch_scc1 FINDONE
    s_waitcnt vmcnt(12)
    s_cmp_gt_u32 s28, 0
DGO1:
    s_cbranch_scc1 WK_D10
    s_waitcnt vmcnt(9)
WK_D10:
    v_dot2_f32_bf16 v36, v184, v4, 0
    v_dot2_f32_bf16 v37, v188, v8, 0
    v_dot2_f32_bf16 v38, v192, v12, 0
    v_dot2_f32_bf16 v36, v185, v5, v36
    v_dot2_f32_bf16 v37, v189, v9, v37
    v_dot2_f32_bf16 v38, v193, v13, v38
    v_dot2_f32_bf16 v36, v186, v6, v36
    v_dot2_f32_bf16 v37, v190, v10, v37
    v_dot2_f32_bf16 v38, v194, v14, v38
    v_dot2_f32_bf16 v36, v187, v7, v36
    v_dot2_f32_bf16 v37, v191, v11, v37
    v_dot2_f32_bf16 v38, v195, v15, v38
    s_nop 2
    v_add_f32 v36, v36, v37
    v_add_f32 v36, v36, v38
    s_nop 1
    v_add_f32_dpp v36, v36, v36 quad_perm:[1,0,3,2] row_mask:0xf bank_mask:0xf
    s_nop 1
    v_add_f32_dpp v36, v36, v36 quad_perm:[2,3,0,1] row_mask:0xf bank_mask:0xf
    s_nop 1
    v_add_f32_dpp v36, v36, v36 row_half_mirror row_mask:0xf bank_mask:0xf
    v_fma_f32 v39, v36, s56, v3
    v_cmp_lt_f32 vcc, 0, v39
    s_cbranch_vccz BACK_D10
    s_call_b64 s[38:39], SLOW
BACK_D10:
    v_exp_f32 v39, v39
    s_nop 0
    v_cvt_pk_bf16_f32 v37, v39, v39
    v_add_f32 v2, v2, v39
    v_and_b32 v32, v37, v16
    v_and_b32 v33, v37, v17
    v_and_b32 v34, v37, v18
    v_and_b32 v35, v37, v19
    s_cbranch_scc1 WV_D10
    s_waitcnt vmcnt(6)
WV_D10:
    s_nop 0
    v_mfma_f32_16x16x32_bf16 v[20:23], v[32:35], v[196:199], v[20:23]
    v_mfma_f32_16x16x32_bf16 v[24:27], v[32:35], v[200:203], v[24:27]
    v_mfma_f32_16x16x32_bf16 v[28:31], v[32:35], v[204:207], v[28:31]
    s_cbranch_scc1 WK_D11
    s_waitcnt vmcnt(3)
WK_D11:
    v_dot2_f32_bf16 v36, v208, v4, 0
    v_dot2_f32_bf16 v37, v212, v8, 0
    v_dot2_f32_bf16 v38, v216, v12, 0
    v_dot2_f32_bf16 v36, v209, v5, v36
    v_dot2_f32_bf16 v37, v213, v9, v37
    v_dot2_f32_bf16 v38, v217, v13, v38
    v_dot2_f32_bf16 v36, v210, v6, v36
    v_dot2_f32_bf16 v37, v214, v10, v37
    v_dot2_f32_bf16 v38, v218, v14, v38
    v_dot2_f32_bf16 v36, v211, v7, v36
    v_dot2_f32_bf16 v37, v215, v11, v37
    v_dot2_f32_bf16 v38, v219, v15, v38
    s_nop 2
    v_add_f32 v36, v36, v37
    v_add_f32 v36, v36, v38
    s_nop 1
    v_add_f32_dpp v36, v36, v36 quad_perm:[1,0,3,2] row_mask:0xf bank_mask:0xf
    s_nop 1
    v_add_f32_dpp v36, v36, v36 quad_perm:[2,3,0,1] row_mask:0xf bank_mask:0xf
    s_nop 1
    v_add_f32_dpp v36, v36, v36 row_half_mirror row_mask:0xf bank_mask:0xf
    v_fma_f32 v39, v36, s56, v3
    v_cmp_lt_f32 vcc, 0, v39
    s_cbranch_vccz BACK_D11
    s_call_b64 s[38:39], SLOW
BACK_D11:
    v_exp_f32 v39, v39
    s_nop 0
    v_cvt_pk_bf16_f32 v37, v39, v39
    v_add_f32 v2, v2, v39
    v_and_b32 v32, v37, v16
    v_and_b32 v33, v37, v17
    v_and_b32 v34, v37, v18
    v_and_b32 v35, v37, v19
    s_cbranch_scc1 WV_D11
    s_waitcnt vmcnt(0)
WV_D11:
    s_nop 0
    v_mfma_f32_16x16x32_bf16 v[20:23], v[32:35], v[220:223], v[20:23]
    v_mfma_f32_16x16x32_bf16 v[24:27], v[32:35], v[224:227], v[24:27]
    v_mfma_f32_16x16x32_bf16 v[28:31], v[32:35], v[228:231], v[28:31]
    s_branch DTOP0
FINDONE:
    v_add_f32_dpp v2, v2, v2 row_ror:8 row_mask:0xf bank_mask:0xf
    s_nop 1
    v_add_f32_dpp v2, v2, v2 row_bcast:15 row_mask:0xa bank_mask:0xf
    s_nop 1
    v_add_f32_dpp v2, v2, v2 row_bcast:31 row_mask:0xc bank_mask:0xf
    s_nop 1
    v_readlane_b32 s59, v2, 63
    v_permlane32_swap_b32 v20, v22
    v_permlane32_swap_b32 v21, v23
    v_permlane32_swap_b32 v24, v26
    v_permlane32_swap_b32 v25, v27
    v_permlane32_swap_b32 v28, v30
    v_permlane32_swap_b32 v29, v31
    v_rcp_f32 v40, s59
    v_log_f32 v39, s59
    v_add_f32_dpp v36, v22, v20 row_ror:8 row_mask:0xf bank_mask:0x3
    v_add_f32_dpp v37, v26, v24 row_ror:8 row_mask:0xf bank_mask:0x3
    v_add_f32_dpp v38, v30, v28 row_ror:8 row_mask:0xf bank_mask:0x3
    v_add_f32_dpp v36, v21, v23 row_ror:8 row_mask:0xf bank_mask:0xc
    v_add_f32_dpp v37, v25, v27 row_ror:8 row_mask:0xf bank_mask:0xc
    v_add_f32_dpp v38, v29, v31 row_ror:8 row_mask:0xf bank_mask:0xc
    v_sub_f32 v39, v39, v3
    v_mul_f32 v36, v36, v40
    v_mul_f32 v37, v37, v40
    v_mul_f32 v38, v38, v40
    buffer_store_dwordx4 v[36:39], v232, s[40:43], 0 offen sc1
    s_barrier
    s_branch END
HELPER:
    s_mul_i32 s58, s53, 160
    v_mul_u32_u24 v3, 20, v11
    v_add_u32 v3, s58, v3
    s_mul_i32 s58, s53, 983040
    s_mul_i32 s59, s52, 384
    s_add_u32 s58, s58, s59
    s_mov_b32 s59, 122880
    v_mul_lo_u32 v2, v11, s59
    v_add3_u32 v2, v2, v12, s58
    s_mov_b32 s65, 0
    s_waitcnt lgkmcnt(0)
    s_mov_b32 s36, s4
    s_mov_b32 s37, s5
    s_mov_b32 s38, 1280
    s_mov_b32 s39, 0x20000
    s_mov_b32 s28, s10
    s_mov_b32 s29, s11
    s_mov_b32 s30, 7864320
    s_mov_b32 s31, 0x20000
    buffer_load_dwordx4 v[4:7], v3, s[36:39], 0 offen
    buffer_load_dword v8, v3, s[36:39], 0 offen offset:16
    buffer_load_dwordx4 v[136:139], v2, s[28:31], s65 offen nt
    buffer_load_dwordx4 v[140:143], v2, s[28:31], s65 offen offset:128 nt
    buffer_load_dwordx4 v[144:147], v2, s[28:31], s65 offen offset:256 nt
    s_add_u32 s65, s65, 12288
    buffer_load_dwordx4 v[148:151], v2, s[28:31], s65 offen nt
    buffer_load_dwordx4 v[152:155], v2, s[28:31], s65 offen offset:128 nt
    buffer_load_dwordx4 v[156:159], v2, s[28:31], s65 offen offset:256 nt
    s_add_u32 s65, s65, 12288
    buffer_load_dwordx4 v[160:163], v2, s[28:31], s65 offen nt
    buffer_load_dwordx4 v[164:167], v2, s[28:31], s65 offen offset:128 nt
    buffer_load_dwordx4 v[168:171], v2, s[28:31], s65 offen offset:256 nt
    s_add_u32 s65, s65, 12288
    buffer_load_dwordx4 v[172:175], v2, s[28:31], s65 offen nt
    buffer_load_dwordx4 v[176:179], v2, s[28:31], s65 offen offset:128 nt
    buffer_load_dwordx4 v[180:183], v2, s[28:31], s65 offen offset:256 nt
    s_add_u32 s65, s65, 12288
    buffer_load_dwordx4 v[184:187], v2, s[28:31], s65 offen nt
    buffer_load_dwordx4 v[188:191], v2, s[28:31], s65 offen offset:128 nt
    buffer_load_dwordx4 v[192:195], v2, s[28:31], s65 offen offset:256 nt
    s_add_u32 s65, s65, 12288
    buffer_load_dwordx4 v[196:199], v2, s[28:31], s65 offen nt
    buffer_load_dwordx4 v[200:203], v2, s[28:31], s65 offen offset:128 nt
    buffer_load_dwordx4 v[204:207], v2, s[28:31], s65 offen offset:256 nt
    s_add_u32 s65, s65, 12288
    buffer_load_dwordx4 v[208:211], v2, s[28:31], s65 offen nt
    buffer_load_dwordx4 v[212:215], v2, s[28:31], s65 offen offset:128 nt
    buffer_load_dwordx4 v[216:219], v2, s[28:31], s65 offen offset:256 nt
    s_add_u32 s65, s65, 12288
    buffer_load_dwordx4 v[220:223], v2, s[28:31], s65 offen nt
    buffer_load_dwordx4 v[224:227], v2, s[28:31], s65 offen offset:128 nt
    buffer_load_dwordx4 v[228:231], v2, s[28:31], s65 offen offset:256 nt
    s_add_u32 s65, s65, 12288
    buffer_load_dwordx4 v[232:235], v2, s[28:31], s65 offen nt
    buffer_load_dwordx4 v[236:239], v2, s[28:31], s65 offen offset:128 nt
    buffer_load_dwordx4 v[240:243], v2, s[28:31], s65 offen offset:256 nt
    s_add_u32 s65, s65, 12288
    buffer_load_dwordx4 v[244:247], v2, s[28:31], s65 offen nt
    buffer_load_dwordx4 v[248:251], v2, s[28:31], s65 offen offset:128 nt
    buffer_load_dwordx4 v[252:255], v2, s[28:31], s65 offen offset:256 nt
    s_mov_b32 s40, s18
    s_mov_b32 s41, s19
    s_mov_b32 s42, 2752512
    s_mov_b32 s43, 0x20000
    s_mov_b32 s58, 0x280000
    buffer_load_dword v40, off, s[40:43], s58 sc1
    s_mul_i32 s58, s54, 8448
    v_lshlrev_b32 v41, 4, v0
    v_add_u32 v41, s58, v41
    v_mov_b32 v36, -1
    v_mov_b32 v37, -1
    v_mov_b32 v38, -1
    v_mov_b32 v39, -1
    buffer_store_dwordx4 v[36:39], v41, s[40:43], 0 offen sc1
    buffer_store_dwordx4 v[36:39], v41, s[40:43], 0 offen offset:1024 sc1
    buffer_store_dwordx4 v[36:39], v41, s[40:43], 0 offen offset:2048 sc1
    buffer_store_dwordx4 v[36:39], v41, s[40:43], 0 offen offset:3072 sc1
    s_movk_i32 s65, 4096
    s_cmp_lt_u32 s2, 160
    s_cselect_b64 exec, -1, 0
    buffer_store_dwordx4 v[36:39], v41, s[40:43], s65 offen sc1
    buffer_store_dwordx4 v[36:39], v41, s[40:43], s65 offen offset:1024 sc1
    buffer_store_dwordx4 v[36:39], v41, s[40:43], s65 offen offset:2048 sc1
    buffer_store_dwordx4 v[36:39], v41, s[40:43], s65 offen offset:3072 sc1
    s_mov_b64 exec, -1
    s_lshl_b32 s64, s52, 2
    s_add_u32 s64, s64, s53
    s_mul_i32 s64, s64, 256
    s_add_u32 s64, s64, 0x27f800
    v_mov_b32 v43, v41
    v_writelane_b32 v43, s64, 34
    s_cmp_lt_u32 s53, 4
    s_cselect_b32 exec_hi, 4, 0
    s_mov_b32 exec_lo, 0
    buffer_store_dwordx4 v[36:39], v43, s[40:43], s65 offen offset:2048 sc1
    s_mov_b64 exec, -1
    s_barrier
    s_mov_b32 s32, s12
    s_mov_b32 s33, s13
    s_mov_b32 s34, 7864320
    s_mov_b32 s35, 0x20000
    s_mov_b32 s48, s16
    s_mov_b32 s49, s17
    s_mov_b32 s50, 256
    s_mov_b32 s51, 0x20000
    s_mov_b32 s44, s14
    s_mov_b32 s45, s15
    s_mov_b32 s46, 1280
    s_mov_b32 s47, 0x20000
    s_mov_b32 s62, 0x01000100
    s_mov_b32 s63, 0x03020302
    v_and_b32 v13, 1, v10
    v_lshlrev_b32 v13, 4, v13
    v_mov_b32 v14, 0xffff
    v_lshlrev_b32 v13, v13, v14
    v_lshrrev_b32 v14, 1, v10
    v_cmp_eq_u32 vcc, 0, v14
    s_nop 1
    v_cndmask_b32 v16, 0, v13, vcc
    v_cmp_eq_u32 vcc, 1, v14
    s_nop 1
    v_cndmask_b32 v17, 0, v13, vcc
    v_cmp_eq_u32 vcc, 2, v14
    s_nop 1
    v_cndmask_b32 v18, 0, v13, vcc
    v_cmp_eq_u32 vcc, 3, v14
    s_nop 1
    v_cndmask_b32 v19, 0, v13, vcc
    v_lshrrev_b32 v42, 4, v0
    v_lshlrev_b32 v42, 7, v42
    v_add_u32 v42, v42, v12
    s_mul_i32 s58, s54, 1536
    s_add_u32 s58, s58, 0x220000
    v_bfe_u32 v43, v0, 3, 1
    v_mul_u32_u24 v43, 0x1800, v43
    s_mul_i32 s59, s52, 12288
    s_add_u32 s59, s59, 0x220000
    v_add3_u32 v43, v43, v42, s59
    s_waitcnt vmcnt(37)
    v_perm_b32 v9, v4, v4, s62
    v_and_b32 v32, v9, v16
    v_and_b32 v33, v9, v17
    v_and_b32 v34, v9, v18
    v_and_b32 v35, v9, v19
    s_nop 1
    v_mfma_f32_16x16x32_bf16 v[20:23], v[32:35], v[136:139], 0
    v_mfma_f32_16x16x32_bf16 v[24:27], v[32:35], v[140:143], 0
    v_mfma_f32_16x16x32_bf16 v[28:31], v[32:35], v[144:147], 0
    s_waitcnt vmcnt(34)
    v_perm_b32 v9, v4, v4, s63
    v_and_b32 v12, v9, v16
    v_and_b32 v13, v9, v17
    v_and_b32 v14, v9, v18
    v_and_b32 v15, v9, v19
    s_nop 1
    v_mfma_f32_16x16x32_bf16 v[20:23], v[12:15], v[148:151], v[20:23]
    v_mfma_f32_16x16x32_bf16 v[24:27], v[12:15], v[152:155], v[24:27]
    v_mfma_f32_16x16x32_bf16 v[28:31], v[12:15], v[156:159], v[28:31]
    s_waitcnt vmcnt(31)
    v_perm_b32 v9, v5, v5, s62
    v_and_b32 v32, v9, v16
    v_and_b32 v33, v9, v17
    v_and_b32 v34, v9, v18
    v_and_b32 v35, v9, v19
    s_nop 1
    v_mfma_f32_16x16x32_bf16 v[20:23], v[32:35], v[160:163], v[20:23]
    v_mfma_f32_16x16x32_bf16 v[24:27], v[32:35], v[164:167], v[24:27]
    v_mfma_f32_16x16x32_bf16 v[28:31], v[32:35], v[168:171], v[28:31]
    s_waitcnt vmcnt(28)
    v_perm_b32 v9, v5, v5, s63
    v_and_b32 v12, v9, v16
    v_and_b32 v13, v9, v17
    v_and_b32 v14, v9, v18
    v_and_b32 v15, v9, v19
    s_nop 1
    v_mfma_f32_16x16x32_bf16 v[20:23], v[12:15], v[172:175], v[20:23]
    v_mfma_f32_16x16x32_bf16 v[24:27], v[12:15], v[176:179], v[24:27]
    v_mfma_f32_16x16x32_bf16 v[28:31], v[12:15], v[180:183], v[28:31]
    s_waitcnt vmcnt(25)
    v_perm_b32 v9, v6, v6, s62
    v_and_b32 v32, v9, v16
    v_and_b32 v33, v9, v17
    v_and_b32 v34, v9, v18
    v_and_b32 v35, v9, v19
    s_nop 1
    v_mfma_f32_16x16x32_bf16 v[20:23], v[32:35], v[184:187], v[20:23]
    v_mfma_f32_16x16x32_bf16 v[24:27], v[32:35], v[188:191], v[24:27]
    v_mfma_f32_16x16x32_bf16 v[28:31], v[32:35], v[192:195], v[28:31]
    s_waitcnt vmcnt(22)
    v_perm_b32 v9, v6, v6, s63
    v_and_b32 v12, v9, v16
    v_and_b32 v13, v9, v17
    v_and_b32 v14, v9, v18
    v_and_b32 v15, v9, v19
    s_nop 1
    v_mfma_f32_16x16x32_bf16 v[20:23], v[12:15], v[196:199], v[20:23]
    v_mfma_f32_16x16x32_bf16 v[24:27], v[12:15], v[200:203], v[24:27]
    v_mfma_f32_16x16x32_bf16 v[28:31], v[12:15], v[204:207], v[28:31]
    s_waitcnt vmcnt(19)
    v_perm_b32 v9, v7, v7, s62
    v_and_b32 v32, v9, v16
    v_and_b32 v33, v9, v17
    v_and_b32 v34, v9, v18
    v_and_b32 v35, v9, v19
    s_nop 1
    v_mfma_f32_16x16x32_bf16 v[20:23], v[32:35], v[208:211], v[20:23]
    v_mfma_f32_16x16x32_bf16 v[24:27], v[32:35], v[212:215], v[24:27]
    v_mfma_f32_16x16x32_bf16 v[28:31], v[32:35], v[216:219], v[28:31]
    s_waitcnt vmcnt(16)
    v_perm_b32 v9, v7, v7, s63
    v_and_b32 v12, v9, v16
    v_and_b32 v13, v9, v17
    v_and_b32 v14, v9, v18
    v_and_b32 v15, v9, v19
    s_nop 1
    v_mfma_f32_16x16x32_bf16 v[20:23], v[12:15], v[220:223], v[20:23]
    v_mfma_f32_16x16x32_bf16 v[24:27], v[12:15], v[224:227], v[24:27]
    v_mfma_f32_16x16x32_bf16 v[28:31], v[12:15], v[228:231], v[28:31]
    s_waitcnt vmcnt(13)
    v_perm_b32 v9, v8, v8, s62
    v_and_b32 v32, v9, v16
    v_and_b32 v33, v9, v17
    v_and_b32 v34, v9, v18
    v_and_b32 v35, v9, v19
    s_nop 1
    v_mfma_f32_16x16x32_bf16 v[20:23], v[32:35], v[232:235], v[20:23]
    v_mfma_f32_16x16x32_bf16 v[24:27], v[32:35], v[236:239], v[24:27]
    v_mfma_f32_16x16x32_bf16 v[28:31], v[32:35], v[240:243], v[28:31]
    s_waitcnt vmcnt(10)
    v_perm_b32 v9, v8, v8, s63
    v_and_b32 v12, v9, v16
    v_and_b32 v13, v9, v17
    v_and_b32 v14, v9, v18
    v_and_b32 v15, v9, v19
    s_nop 1
    v_mfma_f32_16x16x32_bf16 v[20:23], v[12:15], v[244:247], v[20:23]
    v_mfma_f32_16x16x32_bf16 v[24:27], v[12:15], v[248:251], v[24:27]
    v_mfma_f32_16x16x32_bf16 v[28:31], v[12:15], v[252:255], v[28:31]
    s_waitcnt vmcnt(0)
    v_add_u32 v40, 0x9e3779b9, v40
    s_nop 5
    v_permlane32_swap_b32 v20, v22
    v_permlane32_swap_b32 v21, v23
    v_permlane32_swap_b32 v24, v26
    v_permlane32_swap_b32 v25, v27
    v_permlane32_swap_b32 v28, v30
    v_permlane32_swap_b32 v29, v31
    s_nop 0
    v_add_f32_dpp v20, v22, v20 row_ror:8 row_mask:0xf bank_mask:0xf
    v_add_f32_dpp v21, v23, v21 row_ror:8 row_mask:0xf bank_mask:0xf
    v_add_f32_dpp v24, v26, v24 row_ror:8 row_mask:0xf bank_mask:0xf
    v_add_f32_dpp v25, v27, v25 row_ror:8 row_mask:0xf bank_mask:0xf
    v_add_f32_dpp v28, v30, v28 row_ror:8 row_mask:0xf bank_mask:0xf
    v_add_f32_dpp v29, v31, v29 row_ror:8 row_mask:0xf bank_mask:0xf
    v_mov_b32 v22, v21
    v_mov_b32 v26, v25
    v_mov_b32 v30, v29
    v_mov_b32 v21, v40
    v_mov_b32 v23, v40
    v_mov_b32 v25, v40
    v_mov_b32 v27, v40
    v_mov_b32 v29, v40
    v_mov_b32 v31, v40
    s_mov_b32 exec_lo, 0x00ff00ff
    s_mov_b32 exec_hi, 0x00ff00ff
    buffer_store_dwordx4 v[20:23], v42, s[40:43], s58 offen sc1
    buffer_store_dwordx4 v[24:27], v42, s[40:43], s58 offen offset:512 sc1
    buffer_store_dwordx4 v[28:31], v42, s[40:43], s58 offen offset:1024 sc1
    s_mov_b64 exec, -1
    s_mov_b32 s57, 0
    s_movk_i32 s64, 3072
QPOLL:
    buffer_load_dwordx4 v[44:47], v43, s[40:43], 0 offen sc1
    buffer_load_dwordx4 v[48:51], v43, s[40:43], 0 offen offset:512 sc1
    buffer_load_dwordx4 v[52:55], v43, s[40:43], 0 offen offset:1024 sc1
    buffer_load_dwordx4 v[56:59], v43, s[40:43], 0 offen offset:1536 sc1
    buffer_load_dwordx4 v[60:63], v43, s[40:43], 0 offen offset:2048 sc1
    buffer_load_dwordx4 v[64:67], v43, s[40:43], 0 offen offset:2560 sc1
    buffer_load_dwordx4 v[68:71], v43, s[40:43], s64 offen sc1
    buffer_load_dwordx4 v[72:75], v43, s[40:43], s64 offen offset:512 sc1
    buffer_load_dwordx4 v[76:79], v43, s[40:43], s64 offen offset:1024 sc1
    buffer_load_dwordx4 v[80:83], v43, s[40:43], s64 offen offset:1536 sc1
    buffer_load_dwordx4 v[84:87], v43, s[40:43], s64 offen offset:2048 sc1
    buffer_load_dwordx4 v[88:91], v43, s[40:43], s64 offen offset:2560 sc1
    s_add_u32 s57, s57, 1
    v_mov_b32 v7, 0
    s_waitcnt vmcnt(11)
    v_xor_b32 v8, v45, v40
    v_xor_b32 v9, v47, v40
    v_or3_b32 v7, v7, v8, v9
    s_waitcnt vmcnt(10)
    v_xor_b32 v8, v49, v40
    v_xor_b32 v9, v51, v40
    v_or3_b32 v7, v7, v8, v9
    s_waitcnt vmcnt(9)
    v_xor_b32 v8, v53, v40
    v_xor_b32 v9, v55, v40
    v_or3_b32 v7, v7, v8, v9
    s_waitcnt vmcnt(8)
    v_xor_b32 v8, v57, v40
    v_xor_b32 v9, v59, v40
    v_or3_b32 v7, v7, v8, v9
    s_waitcnt vmcnt(7)
    v_xor_b32 v8, v61, v40
    v_xor_b32 v9, v63, v40
    v_or3_b32 v7, v7, v8, v9
    s_waitcnt vmcnt(6)
    v_xor_b32 v8, v65, v40
    v_xor_b32 v9, v67, v40
    v_or3_b32 v7, v7, v8, v9
    s_waitcnt vmcnt(5)
    v_xor_b32 v8, v69, v40
    v_xor_b32 v9, v71, v40
    v_or3_b32 v7, v7, v8, v9
    s_waitcnt vmcnt(4)
    v_xor_b32 v8, v73, v40
    v_xor_b32 v9, v75, v40
    v_or3_b32 v7, v7, v8, v9
    s_waitcnt vmcnt(3)
    v_xor_b32 v8, v77, v40
    v_xor_b32 v9, v79, v40
    v_or3_b32 v7, v7, v8, v9
    s_waitcnt vmcnt(2)
    v_xor_b32 v8, v81, v40
    v_xor_b32 v9, v83, v40
    v_or3_b32 v7, v7, v8, v9
    s_waitcnt vmcnt(1)
    v_xor_b32 v8, v85, v40
    v_xor_b32 v9, v87, v40
    v_or3_b32 v7, v7, v8, v9
    s_waitcnt vmcnt(0)
    v_xor_b32 v8, v89, v40
    v_xor_b32 v9, v91, v40
    v_or3_b32 v7, v7, v8, v9
    v_cmp_ne_u32 vcc, 0, v7
    s_mov_b64 exec, vcc
    s_cbranch_execz QPOLL_DONE
    s_cmp_lt_u32 s57, 0x8000
    s_cbranch_scc1 QPOLL
QPOLL_DONE:
    s_mov_b64 exec, -1
    v_add_f32 v44, v44, v68
    v_add_f32 v46, v46, v70
    v_add_f32 v48, v48, v72
    v_add_f32 v50, v50, v74
    v_add_f32 v52, v52, v76
    v_add_f32 v54, v54, v78
    v_add_f32 v56, v56, v80
    v_add_f32 v58, v58, v82
    v_add_f32 v60, v60, v84
    v_add_f32 v62, v62, v86
    v_add_f32 v64, v64, v88
    v_add_f32 v66, v66, v90
    v_add_f32 v44, v44, v56
    v_add_f32 v46, v46, v58
    v_add_f32 v48, v48, v60
    v_add_f32 v50, v50, v62
    v_add_f32 v52, v52, v64
    v_add_f32 v54, v54, v66
    v_add_f32_dpp v44, v44, v44 row_ror:8 row_mask:0xf bank_mask:0xf
    v_add_f32_dpp v46, v46, v46 row_ror:8 row_mask:0xf bank_mask:0xf
    v_add_f32_dpp v48, v48, v48 row_ror:8 row_mask:0xf bank_mask:0xf
    v_add_f32_dpp v50, v50, v50 row_ror:8 row_mask:0xf bank_mask:0xf
    v_add_f32_dpp v52, v52, v52 row_ror:8 row_mask:0xf bank_mask:0xf
    v_add_f32_dpp v54, v54, v54 row_ror:8 row_mask:0xf bank_mask:0xf
    v_bfe_u32 v4, v0, 4, 1
    v_lshlrev_b32 v4, 3, v4
    v_bfe_u32 v5, v0, 5, 1
    v_lshlrev_b32 v5, 2, v5
    v_and_b32 v6, 7, v0
    v_lshlrev_b32 v6, 4, v6
    v_add3_u32 v4, v4, v5, v6
    v_cvt_pk_bf16_f32 v44, v44, v46
    v_cvt_pk_bf16_f32 v48, v48, v50
    v_cvt_pk_bf16_f32 v52, v52, v54
    ds_write_b32 v4, v44 offset:0
    ds_write_b32 v4, v48 offset:128
    ds_write_b32 v4, v52 offset:256
    s_waitcnt lgkmcnt(0)
    s_barrier
    s_cmp_lg_u32 s53, 0
    s_cbranch_scc1 NOCNT
    s_mov_b64 exec, 1
    v_mov_b32 v10, 1
    buffer_atomic_add v10, off, s[48:51], 0 sc1
    s_mov_b64 exec, -1
NOCNT:
    s_bfe_u32 s58, s53, 0x10001
    s_lshl_b32 s58, s58, 2
    s_lshr_b32 s59, s53, 2
    s_lshl_b32 s59, s59, 1
    s_add_u32 s58, s58, s59
    s_and_b32 s59, s53, 1
    s_add_u32 s58, s58, s59
    s_mul_i32 s59, s52, 192
    s_add_u32 s58, s58, s59
    s_mul_i32 s58, s58, 1280
    v_lshrrev_b32 v4, 4, v0
    v_mul_u32_u24 v4, 0x5000, v4
    v_and_b32 v5, 15, v0
    v_lshlrev_b32 v6, 4, v5
    v_add3_u32 v4, v4, v6, s58
    s_mov_b32 s59, 0
    buffer_load_dwordx4 v[136:139], v4, s[32:35], s59 offen nt
    buffer_load_dwordx4 v[140:143], v4, s[32:35], s59 offen offset:256 nt
    buffer_load_dwordx4 v[144:147], v4, s[32:35], s59 offen offset:512 nt
    buffer_load_dwordx4 v[148:151], v4, s[32:35], s59 offen offset:768 nt
    buffer_load_dwordx4 v[152:155], v4, s[32:35], s59 offen offset:1024 nt
    s_mov_b32 s59, 81920
    buffer_load_dwordx4 v[156:159], v4, s[32:35], s59 offen nt
    buffer_load_dwordx4 v[160:163], v4, s[32:35], s59 offen offset:256 nt
    buffer_load_dwordx4 v[164:167], v4, s[32:35], s59 offen offset:512 nt
    buffer_load_dwordx4 v[168:171], v4, s[32:35], s59 offen offset:768 nt
    buffer_load_dwordx4 v[172:175], v4, s[32:35], s59 offen offset:1024 nt
    s_mov_b32 s59, 163840
    buffer_load_dwordx4 v[176:179], v4, s[32:35], s59 offen nt
    buffer_load_dwordx4 v[180:183], v4, s[32:35], s59 offen offset:256 nt
    buffer_load_dwordx4 v[184:187], v4, s[32:35], s59 offen offset:512 nt
    buffer_load_dwordx4 v[188:191], v4, s[32:35], s59 offen offset:768 nt
    buffer_load_dwordx4 v[192:195], v4, s[32:35], s59 offen offset:1024 nt
    s_mov_b32 s59, 10240
    buffer_load_dwordx4 v[196:199], v4, s[32:35], s59 offen nt
    buffer_load_dwordx4 v[200:203], v4, s[32:35], s59 offen offset:256 nt
    buffer_load_dwordx4 v[204:207], v4, s[32:35], s59 offen offset:512 nt
    buffer_load_dwordx4 v[208:211], v4, s[32:35], s59 offen offset:768 nt
    buffer_load_dwordx4 v[212:215], v4, s[32:35], s59 offen offset:1024 nt
    s_mov_b32 s59, 92160
    buffer_load_dwordx4 v[216:219], v4, s[32:35], s59 offen nt
    buffer_load_dwordx4 v[220:223], v4, s[32:35], s59 offen offset:256 nt
    buffer_load_dwordx4 v[224:227], v4, s[32:35], s59 offen offset:512 nt
    buffer_load_dwordx4 v[228:231], v4, s[32:35], s59 offen offset:768 nt
    buffer_load_dwordx4 v[232:235], v4, s[32:35], s59 offen offset:1024 nt
    s_mov_b32 s59, 174080
    buffer_load_dwordx4 v[236:239], v4, s[32:35], s59 offen nt
    buffer_load_dwordx4 v[240:243], v4, s[32:35], s59 offen offset:256 nt
    buffer_load_dwordx4 v[244:247], v4, s[32:35], s59 offen offset:512 nt
    buffer_load_dwordx4 v[248:251], v4, s[32:35], s59 offen offset:768 nt
    buffer_load_dwordx4 v[252:255], v4, s[32:35], s59 offen offset:1024 nt
    v_bfe_u32 v6, v0, 4, 1
    v_lshl_add_u32 v5, v5, 1, v6
    v_add_u32 v39, 4096, v41
    s_lshl_b32 s58, s54, 4
    v_mul_u32_u24 v42, 0x2100, v5
    s_add_u32 s58, s58, 4096
    v_add_u32 v42, s58, v42
    s_mul_i32 s58, s52, 67584
    s_lshl_b32 s59, s53, 7
    s_add_u32 s58, s58, s59
    v_lshrrev_b32 v5, 3, v0
    v_and_b32 v6, 7, v0
    v_mul_u32_u24 v41, 0x2100, v5
    v_lshlrev_b32 v7, 4, v6
    v_add3_u32 v41, v41, v7, s58
    v_lshl_add_u32 v38, v6, 3, v5
    v_lshlrev_b32 v38, 2, v38
    s_mov_b32 s28, 270336
    s_mov_b32 s29, 540672
    s_mov_b32 s30, 811008
    s_mov_b32 s31, 1081344
    s_waitcnt vmcnt(0)
    s_mov_b64 s[20:21], -1
    s_mov_b64 s[22:23], -1
    s_mov_b64 s[24:25], -1
    s_mov_b64 s[26:27], -1
    s_mov_b32 s57, 0
    s_barrier
    buffer_load_dword v43, off, s[48:51], 0 sc1
OPOLL:
    s_mov_b64 exec, s[20:21]
    buffer_load_dwordx4 v[44:47], v41, s[40:43], 0 offen sc1
    s_mov_b64 exec, s[22:23]
    buffer_load_dwordx4 v[48:51], v41, s[40:43], 0 offen offset:1024 sc1
    s_mov_b64 exec, s[24:25]
    buffer_load_dwordx4 v[52:55], v41, s[40:43], 0 offen offset:2048 sc1
    s_mov_b64 exec, s[26:27]
    buffer_load_dwordx4 v[56:59], v41, s[40:43], 0 offen offset:3072 sc1
    s_mov_b64 exec, -1
    s_add_u32 s57, s57, 1
    s_waitcnt vmcnt(3)
    v_max3_u32 v10, v44, v45, v46
    v_max_u32 v10, v47, v10
    v_cmp_eq_u32_e64 s[20:21], -1, v10
    s_waitcnt vmcnt(2)
    v_max3_u32 v10, v48, v49, v50
    v_max_u32 v10, v51, v10
    v_cmp_eq_u32_e64 s[22:23], -1, v10
    s_waitcnt vmcnt(1)
    v_max3_u32 v10, v52, v53, v54
    v_max_u32 v10, v55, v10
    v_cmp_eq_u32_e64 s[24:25], -1, v10
    s_waitcnt vmcnt(0)
    v_max3_u32 v10, v56, v57, v58
    v_max_u32 v10, v59, v10
    v_cmp_eq_u32_e64 s[26:27], -1, v10
    s_or_b64 vcc, s[20:21], s[22:23]
    s_or_b64 vcc, vcc, s[24:25]
    s_or_b64 vcc, vcc, s[26:27]
    s_cbranch_scc0 OPOLL_DONE
    s_cmp_lt_u32 s57, 0x8000
    s_cbranch_scc1 OPOLL
OPOLL_DONE:
    v_max3_f32 v10, v47, v51, v55
    v_readfirstlane_b32 s58, v43
    v_max_f32 v10, v59, v10
    s_ff1_i32_b32 s58, s58
    s_cmp_lt_i32 s58, 5
    s_cbranch_scc1 CNT_SLOW
CNT_OK:
    v_max_f32_dpp v10, v10, v10 row_ror:8 row_mask:0xf bank_mask:0xf
    s_nop 1
    v_max_f32_dpp v10, v10, v10 row_bcast:15 row_mask:0xa bank_mask:0xf
    s_nop 1
    v_max_f32_dpp v10, v10, v10 row_bcast:31 row_mask:0xc bank_mask:0xf
    s_nop 1
    v_readlane_b32 s58, v10, 63
    s_nop 1
    v_subrev_f32 v47, s58, v47
    v_subrev_f32 v51, s58, v51
    v_subrev_f32 v55, s58, v55
    v_subrev_f32 v59, s58, v59
    v_exp_f32 v47, v47
    v_exp_f32 v51, v51
    v_exp_f32 v55, v55
    v_exp_f32 v59, v59
    v_mul_f32 v4, v44, v47
    v_mul_f32 v5, v45, v47
    v_mul_f32 v6, v46, v47
    v_add_f32 v12, v47, v51
    v_fma_f32 v4, v48, v51, v4
    v_fma_f32 v5, v49, v51, v5
    v_fma_f32 v6, v50, v51, v6
    v_add_f32 v13, v55, v59
    v_fma_f32 v4, v52, v55, v4
    v_fma_f32 v5, v53, v55, v5
    v_fma_f32 v6, v54, v55, v6
    v_add_f32 v12, v12, v13
    ds_bpermute_b32 v12, v38, v12
    v_fma_f32 v4, v56, v59, v4
    v_fma_f32 v5, v57, v59, v5
    v_fma_f32 v6, v58, v59, v6
    ds_bpermute_b32 v4, v38, v4
    ds_bpermute_b32 v5, v38, v5
    ds_bpermute_b32 v6, v38, v6
    s_waitcnt lgkmcnt(0)
    v_add_f32_dpp v12, v12, v12 quad_perm:[1,0,3,2] row_mask:0xf bank_mask:0xf
    v_add_f32_dpp v4, v4, v4 quad_perm:[1,0,3,2] row_mask:0xf bank_mask:0xf
    v_add_f32_dpp v5, v5, v5 quad_perm:[1,0,3,2] row_mask:0xf bank_mask:0xf
    v_add_f32_dpp v6, v6, v6 quad_perm:[1,0,3,2] row_mask:0xf bank_mask:0xf
    v_add_f32_dpp v12, v12, v12 quad_perm:[2,3,0,1] row_mask:0xf bank_mask:0xf
    v_add_f32_dpp v4, v4, v4 quad_perm:[2,3,0,1] row_mask:0xf bank_mask:0xf
    v_add_f32_dpp v5, v5, v5 quad_perm:[2,3,0,1] row_mask:0xf bank_mask:0xf
    v_add_f32_dpp v6, v6, v6 quad_perm:[2,3,0,1] row_mask:0xf bank_mask:0xf
    v_add_f32_dpp v12, v12, v12 row_half_mirror row_mask:0xf bank_mask:0xf
    v_add_f32_dpp v4, v4, v4 row_half_mirror row_mask:0xf bank_mask:0xf
    v_rcp_f32 v11, v12
    v_add_f32_dpp v5, v5, v5 row_half_mirror row_mask:0xf bank_mask:0xf
    v_add_f32_dpp v6, v6, v6 row_half_mirror row_mask:0xf bank_mask:0xf
    v_mul_f32 v4, v4, v11
    v_mul_f32 v5, v5, v11
    v_mul_f32 v6, v6, v11
    v_cvt_pk_bf16_f32 v4, v4, v4
    v_cvt_pk_bf16_f32 v5, v5, v5
    v_cvt_pk_bf16_f32 v6, v6, v6
    v_and_b32 v72, v4, v16
    v_and_b32 v73, v4, v17
    v_and_b32 v74, v4, v18
    v_and_b32 v75, v4, v19
    v_mov_b32_dpp v7, v4 row_ror:8 row_mask:0xf bank_mask:0xf
    v_mov_b32_dpp v8, v5 row_ror:8 row_mask:0xf bank_mask:0xf
    v_mov_b32_dpp v9, v6 row_ror:8 row_mask:0xf bank_mask:0xf
    v_and_b32 v76, v5, v16
    v_and_b32 v77, v5, v17
    v_and_b32 v78, v5, v18
    v_and_b32 v79, v5, v19
    v_mfma_f32_16x16x32_bf16 v[20:23], v[72:75], v[136:139], 0
    v_mfma_f32_16x16x32_bf16 v[24:27], v[72:75], v[140:143], 0
    v_mfma_f32_16x16x32_bf16 v[28:31], v[72:75], v[144:147], 0
    v_mfma_f32_16x16x32_bf16 v[64:67], v[72:75], v[148:151], 0
    v_mfma_f32_16x16x32_bf16 v[68:71], v[72:75], v[152:155], 0
    v_and_b32 v80, v6, v16
    v_and_b32 v81, v6, v17
    v_and_b32 v82, v6, v18
    v_and_b32 v83, v6, v19
    v_mfma_f32_16x16x32_bf16 v[20:23], v[76:79], v[156:159], v[20:23]
    v_mfma_f32_16x16x32_bf16 v[24:27], v[76:79], v[160:163], v[24:27]
    v_mfma_f32_16x16x32_bf16 v[28:31], v[76:79], v[164:167], v[28:31]
    v_mfma_f32_16x16x32_bf16 v[64:67], v[76:79], v[168:171], v[64:67]
    v_mfma_f32_16x16x32_bf16 v[68:71], v[76:79], v[172:175], v[68:71]
    v_and_b32 v84, v7, v16
    v_and_b32 v85, v7, v17
    v_and_b32 v86, v7, v18
    v_and_b32 v87, v7, v19
    v_mfma_f32_16x16x32_bf16 v[20:23], v[80:83], v[176:179], v[20:23]
    v_mfma_f32_16x16x32_bf16 v[24:27], v[80:83], v[180:183], v[24:27]
    v_mfma_f32_16x16x32_bf16 v[28:31], v[80:83], v[184:187], v[28:31]
    v_mfma_f32_16x16x32_bf16 v[64:67], v[80:83], v[188:191], v[64:67]
    v_mfma_f32_16x16x32_bf16 v[68:71], v[80:83], v[192:195], v[68:71]
    v_and_b32 v88, v8, v16
    v_and_b32 v89, v8, v17
    v_and_b32 v90, v8, v18
    v_and_b32 v91, v8, v19
    v_mfma_f32_16x16x32_bf16 v[20:23], v[84:87], v[196:199], v[20:23]
    v_mfma_f32_16x16x32_bf16 v[24:27], v[84:87], v[200:203], v[24:27]
    v_mfma_f32_16x16x32_bf16 v[28:31], v[84:87], v[204:207], v[28:31]
    v_mfma_f32_16x16x32_bf16 v[64:67], v[84:87], v[208:211], v[64:67]
    v_mfma_f32_16x16x32_bf16 v[68:71], v[84:87], v[212:215], v[68:71]
    v_and_b32 v92, v9, v16
    v_and_b32 v93, v9, v17
    v_and_b32 v94, v9, v18
    v_and_b32 v95, v9, v19
    v_mfma_f32_16x16x32_bf16 v[20:23], v[88:91], v[216:219], v[20:23]
    v_mfma_f32_16x16x32_bf16 v[24:27], v[88:91], v[220:223], v[24:27]
    v_mfma_f32_16x16x32_bf16 v[28:31], v[88:91], v[224:227], v[28:31]
    v_mfma_f32_16x16x32_bf16 v[64:67], v[88:91], v[228:231], v[64:67]
    v_mfma_f32_16x16x32_bf16 v[68:71], v[88:91], v[232:235], v[68:71]
    v_mfma_f32_16x16x32_bf16 v[20:23], v[92:95], v[236:239], v[20:23]
    v_mfma_f32_16x16x32_bf16 v[24:27], v[92:95], v[240:243], v[24:27]
    v_mfma_f32_16x16x32_bf16 v[28:31], v[92:95], v[244:247], v[28:31]
    v_mfma_f32_16x16x32_bf16 v[64:67], v[92:95], v[248:251], v[64:67]
    v_mfma_f32_16x16x32_bf16 v[68:71], v[92:95], v[252:255], v[68:71]
    s_mov_b32 exec_hi, 0
    s_nop 2
    buffer_store_dwordx4 v[20:23], v42, s[40:43], 0 offen sc1
    s_nop 0
    buffer_store_dwordx4 v[24:27], v42, s[40:43], s28 offen sc1
    s_nop 0
    buffer_store_dwordx4 v[28:31], v42, s[40:43], s29 offen sc1
    s_nop 0
    buffer_store_dwordx4 v[64:67], v42, s[40:43], s30 offen sc1
    s_nop 0
    buffer_store_dwordx4 v[68:71], v42, s[40:43], s31 offen sc1
    s_cmp_ge_u32 s2, 160
    s_cbranch_scc1 END
    s_mov_b64 s[20:21], -1
    s_mov_b64 s[22:23], -1
    s_mov_b64 s[24:25], -1
    s_mov_b64 s[26:27], -1
    s_mov_b32 s57, 0
YPOLL:
    s_mov_b64 exec, s[20:21]
    buffer_load_dwordx4 v[44:47], v39, s[40:43], 0 offen sc1
    s_mov_b64 exec, s[22:23]
    buffer_load_dwordx4 v[48:51], v39, s[40:43], 0 offen offset:1024 sc1
    s_mov_b64 exec, s[24:25]
    buffer_load_dwordx4 v[52:55], v39, s[40:43], 0 offen offset:2048 sc1
    s_mov_b64 exec, s[26:27]
    buffer_load_dwordx4 v[56:59], v39, s[40:43], 0 offen offset:3072 sc1
    s_mov_b64 exec, -1
    s_add_u32 s57, s57, 1
    s_waitcnt vmcnt(3)
    v_max3_u32 v10, v44, v45, v46
    v_max_u32 v10, v47, v10
    v_cmp_eq_u32_e64 s[20:21], -1, v10
    s_waitcnt vmcnt(2)
    v_max3_u32 v10, v48, v49, v50
    v_max_u32 v10, v51, v10
    v_cmp_eq_u32_e64 s[22:23], -1, v10
    s_waitcnt vmcnt(1)
    v_max3_u32 v10, v52, v53, v54
    v_max_u32 v10, v55, v10
    v_cmp_eq_u32_e64 s[24:25], -1, v10
    s_waitcnt vmcnt(0)
    v_max3_u32 v10, v56, v57, v58
    v_max_u32 v10, v59, v10
    v_cmp_eq_u32_e64 s[26:27], -1, v10
    s_or_b64 vcc, s[20:21], s[22:23]
    s_or_b64 vcc, vcc, s[24:25]
    s_or_b64 vcc, vcc, s[26:27]
    s_cbranch_scc0 YPOLL_DONE
    s_cmp_lt_u32 s57, 0x8000
    s_cbranch_scc1 YPOLL
YPOLL_DONE:
    v_add_f32 v44, v44, v48
    v_add_f32 v45, v45, v49
    v_add_f32 v46, v46, v50
    v_add_f32 v47, v47, v51
    v_add_f32 v52, v52, v56
    v_add_f32 v53, v53, v57
    v_add_f32 v54, v54, v58
    v_add_f32 v55, v55, v59
    v_add_f32 v44, v44, v52
    v_add_f32 v45, v45, v53
    v_add_f32 v46, v46, v54
    v_add_f32 v47, v47, v55
    v_add_f32_dpp v44, v44, v44 quad_perm:[1,0,3,2] row_mask:0xf bank_mask:0xf
    v_add_f32_dpp v45, v45, v45 quad_perm:[1,0,3,2] row_mask:0xf bank_mask:0xf
    v_add_f32_dpp v46, v46, v46 quad_perm:[1,0,3,2] row_mask:0xf bank_mask:0xf
    v_add_f32_dpp v47, v47, v47 quad_perm:[1,0,3,2] row_mask:0xf bank_mask:0xf
    v_add_f32_dpp v44, v44, v44 quad_perm:[2,3,0,1] row_mask:0xf bank_mask:0xf
    v_add_f32_dpp v45, v45, v45 quad_perm:[2,3,0,1] row_mask:0xf bank_mask:0xf
    v_add_f32_dpp v46, v46, v46 quad_perm:[2,3,0,1] row_mask:0xf bank_mask:0xf
    v_add_f32_dpp v47, v47, v47 quad_perm:[2,3,0,1] row_mask:0xf bank_mask:0xf
    v_add_f32_dpp v44, v44, v44 row_half_mirror row_mask:0xf bank_mask:0xf
    v_add_f32_dpp v45, v45, v45 row_half_mirror row_mask:0xf bank_mask:0xf
    v_add_f32_dpp v46, v46, v46 row_half_mirror row_mask:0xf bank_mask:0xf
    v_add_f32_dpp v47, v47, v47 row_half_mirror row_mask:0xf bank_mask:0xf
    v_add_f32_dpp v44, v44, v44 row_mirror row_mask:0xf bank_mask:0xf
    v_add_f32_dpp v45, v45, v45 row_mirror row_mask:0xf bank_mask:0xf
    v_add_f32_dpp v46, v46, v46 row_mirror row_mask:0xf bank_mask:0xf
    v_add_f32_dpp v47, v47, v47 row_mirror row_mask:0xf bank_mask:0xf
    v_add_f32_dpp v44, v44, v44 row_bcast:15 row_mask:0xa bank_mask:0xf
    v_add_f32_dpp v45, v45, v45 row_bcast:15 row_mask:0xa bank_mask:0xf
    v_add_f32_dpp v46, v46, v46 row_bcast:15 row_mask:0xa bank_mask:0xf
    v_add_f32_dpp v47, v47, v47 row_bcast:15 row_mask:0xa bank_mask:0xf
    v_add_f32_dpp v44, v44, v44 row_bcast:31 row_mask:0xc bank_mask:0xf
    v_add_f32_dpp v45, v45, v45 row_bcast:31 row_mask:0xc bank_mask:0xf
    v_add_f32_dpp v46, v46, v46 row_bcast:31 row_mask:0xc bank_mask:0xf
    v_add_f32_dpp v47, v47, v47 row_bcast:31 row_mask:0xc bank_mask:0xf
    s_lshl_b32 s59, s2, 3
    v_cvt_pk_bf16_f32 v44, v44, v45
    v_cvt_pk_bf16_f32 v45, v46, v47
    s_mov_b32 exec_lo, 0
    s_mov_b32 exec_hi, 0x80000000
    buffer_store_dwordx2 v[44:45], off, s[44:47], s59
    s_cmp_lg_u32 s2, 0
    s_cbranch_scc1 END
    s_mov_b32 s58, 0x280000
    buffer_store_dword v40, off, s[40:43], s58 sc1
END:
END0:
    s_endpgm
CNT_SLOW:
    s_mov_b32 s57, 0
CNT_LOOP:
    buffer_load_dword v43, off, s[48:51], 0 sc1
    s_add_u32 s57, s57, 1
    s_waitcnt vmcnt(0)
    v_readfirstlane_b32 s58, v43
    s_ff1_i32_b32 s58, s58
    s_cmp_ge_i32 s58, 5
    s_cbranch_scc1 CNT_OK
    s_cmp_lt_u32 s57, 0x8000
    s_cbranch_scc1 CNT_LOOP
    s_branch CNT_OK
.section .rodata,"a"
.p2align 6
.amdhsa_kernel standalone__gqa_block_cached__decode_kernel
  .amdhsa_next_free_vgpr 256
  .amdhsa_next_free_sgpr 100
  .amdhsa_accum_offset 256
  .amdhsa_group_segment_fixed_size 0
  .amdhsa_kernarg_size 64
  .amdhsa_user_sgpr_count 2
  .amdhsa_user_sgpr_kernarg_segment_ptr 1
  .amdhsa_system_sgpr_workgroup_id_x 1
  .amdhsa_float_denorm_mode_32 3
.end_amdhsa_kernel
```
